```python
import torch

def _softmax(x, axis=-1):
    return torch.softmax(x, dim=axis)
def _gelu(x):
    return torch.nn.functional.gelu(x, approximate="tanh")
def _silu(x):
    return torch.nn.functional.silu(x)
def _sigmoid(x):
    return torch.sigmoid(x)
def _layernorm(x, axis=-1, eps=1e-5):
    m = x.mean(dim=axis, keepdim=True)
    v = x.var(dim=axis, keepdim=True, unbiased=False)
    return (x - m) / torch.sqrt(v + eps)
def _scatter_add(tgt, idx, src, axis=0):
    return tgt.clone().index_add_(axis, idx, src)
def _segment_sum(src, seg, n):
    out = torch.zeros((n,) + src.shape[1:], dtype=src.dtype)
    return out.index_add_(0, seg, src)
def _pad(x, pw):
    flat = tuple(v for pair in reversed(pw) for v in pair)
    return torch.nn.functional.pad(x, flat)

kernel_name = 'sequential_preLN__compressed_kv_cla__glu_gated_reglu__decode'

def setup_inputs():

    _w = (lambda a: (lambda t: t.to(torch.bfloat16) if t.is_floating_point() else t)(torch.as_tensor(a)))
    def _A_setup():
        B, H, Sq, Sk, D, M = 4, 32, 1, 4096, 128, 512
        Dc = 4 * D
        return {
            "x": _w((lambda *s: torch.randn(*s, dtype=torch.bfloat16) * 0.05)(B, Sq, M)),
            "c_kv": _w((lambda *s: torch.randn(*s, dtype=torch.bfloat16) * 0.8)(B, Sk, Dc)),
            "w_q": _w((lambda *s: torch.randn(*s, dtype=torch.bfloat16) * 1.6)(M, H, D) * (M ** -0.5)),
            "w_uk": _w((lambda *s: torch.randn(*s, dtype=torch.bfloat16) * 1.6)(Dc, H, D) * (Dc ** -0.5)),
            "w_uv": _w((lambda *s: torch.randn(*s, dtype=torch.bfloat16) * 0.8)(Dc, H, D) * (Dc ** -0.5)),
            "w_o": _w((lambda *s: torch.randn(*s, dtype=torch.bfloat16) * 0.8)(H, D, M) * ((H * D) ** -0.5)),
        }
    _A_in = _A_setup()

    def _B_setup():
        B, S, D, F = 4, 1, 512, 1376
        return {
            "x": _w((lambda *s: torch.randn(*s, dtype=torch.bfloat16) * 0.05)(B, S, D)),
            "W_gate": _w((lambda *s: torch.randn(*s, dtype=torch.bfloat16) * 0.4)(D, F) * (2.0 / D) ** 0.5),
            "W_up": _w((lambda *s: torch.randn(*s, dtype=torch.bfloat16) * 0.4)(D, F) * (2.0 / D) ** 0.5),
            "W_down": _w((lambda *s: torch.randn(*s, dtype=torch.bfloat16) * 0.4)(F, D) * (1.0 / F) ** 0.5),
        }
    _B_in = _B_setup()

    return {
        "A_x": _A_in["x"],
        "A_c_kv": _A_in["c_kv"],
        "A_w_q": _A_in["w_q"],
        "A_w_uk": _A_in["w_uk"],
        "A_w_uv": _A_in["w_uv"],
        "A_w_o": _A_in["w_o"],
        "B_x": _B_in["x"],
        "B_W_gate": _B_in["W_gate"],
        "B_W_up": _B_in["W_up"],
        "B_W_down": _B_in["W_down"],
    }

def reference(A_x, A_c_kv, A_w_q, A_w_uk, A_w_uv, A_w_o, B_x, B_W_gate, B_W_up, B_W_down):
    def _A_ref(x, c_kv, w_q, w_uk, w_uv, w_o):
        B, Sq, M = x.shape[0], x.shape[1], x.shape[2]
        Sk = c_kv.shape[1]
        H, D = w_q.shape[1], w_q.shape[2]
        q = torch.einsum("bqm,mhd->bhqd", x, w_q)
        k = torch.einsum("bkc,chd->bhkd", c_kv, w_uk)
        v = torch.einsum("bkc,chd->bhkd", c_kv, w_uv)
        scores = torch.einsum("bhqd,bhkd->bhqk", q, k) * (D ** -0.5)
        off = Sk - Sq
        qi = torch.arange(Sq)[:, None]
        kj = torch.arange(Sk)[None, :]
        cmask = kj <= (qi + off)
        scores = torch.where(cmask[None, None], scores, -1e9)
        p = _softmax(scores, axis=-1)
        ctx = torch.einsum("bhqk,bhkd->bhqd", p, v)
        return torch.einsum("bhqd,hdm->bqm", ctx, w_o)

    def _B_ref(x, W_gate, W_up, W_down):
        gate = torch.einsum("bsd,df->bsf", x, W_gate)
        up = torch.einsum("bsd,df->bsf", x, W_up)
        gate = gate * (lambda x, dt: x.to(dt))(gate > 0, gate.dtype)
        h = gate * up
        return torch.einsum("bsf,fd->bsd", h, W_down)

    x = A_x
    h = x + _A_ref(_layernorm(x, axis=-1), A_c_kv, A_w_q, A_w_uk, A_w_uv, A_w_o)
    h2 = h + _B_ref(_layernorm(h, axis=-1), B_W_gate, B_W_up, B_W_down)
    return h2
```

```asm
; @launch grid=(256,1,1) block=(256,1,1) lds=163840
.amdgcn_target "amdgcn-amd-amdhsa--gfx950"
.text
.globl sequential_preLN__compressed_kv_cla__glu_gated_reglu__decode_kernel
.p2align 8
.type sequential_preLN__compressed_kv_cla__glu_gated_reglu__decode_kernel,@function
sequential_preLN__compressed_kv_cla__glu_gated_reglu__decode_kernel:
    s_cmp_ge_u32 s2, 0x100
    s_cbranch_scc1 L_end
    s_load_dwordx16 s[4:19], s[0:1], 0x0
    s_load_dwordx8 s[20:27], s[0:1], 0x40
    s_load_dwordx2 s[28:29], s[0:1], 0x60
    s_getpc_b64 s[34:35]
L_pc:
    v_lshrrev_b32 v1, 6, v0
    v_and_b32 v0, 63, v0
    s_and_b32 s30, s2, 7
    s_lshr_b32 s31, s2, 3
    v_readfirstlane_b32 s33, v1
    s_mov_b32 s55, 0
    s_lshl_b32 s51, s31, 10
    v_lshlrev_b32 v2, 2, v0
    v_lshl_add_u32 v2, v1, 8, v2
    v_add_u32 v2, s51, v2
    v_min_u32 v2, L_code_end-L_pc-4, v2
    global_load_dword v3, v2, s[34:35]
    s_cmp_ge_u32 s31, 16
    s_cbranch_scc1 L_A
L_W:
    s_lshr_b32 s51, s31, 2
    s_lshl_b32 s48, s30, 2
    s_add_u32 s48, s48, s51
    s_and_b32 s49, s31, 3
    s_mov_b32 s72, s49
    s_mov_b32 s73, s49
    s_mov_b32 s74, s49
    v_lshlrev_b32 v118, 4, v0
    s_lshl_b32 s52, s33, 10
    v_add_u32 v13, s52, v118
    v_lshrrev_b32 v16, 5, v0
    v_lshlrev_b32 v16, 1, v16
    v_and_b32 v17, 3, v0
    v_xor_b32 v16, v16, v17
    v_lshlrev_b32 v16, 4, v16
    v_lshrrev_b32 v17, 2, v0
    v_lshl_add_u32 v119, v17, 13, v16
    s_lshl_b32 s51, s48, 8
    s_lshl_b32 s52, s33, 6
    s_add_u32 s52, s52, s51
    s_lshl_b32 m0, s33, 15
    s_lshl_b32 s50, s49, 20
    s_waitcnt lgkmcnt(0)
    global_load_dwordx4 v[4:7], v13, s[4:5]
    s_mov_b32 s36, s8
    s_mov_b32 s37, s9
    s_add_u32 s36, s36, s52
    s_addc_u32 s37, s37, 0
    s_mov_b32 s38, 0x400000
    s_mov_b32 s39, 0x20000
    buffer_load_dwordx4 v119, s[36:39], s50 offen lds
    s_add_u32 m0, m0, 0x400
    s_add_u32 s50, s50, 0x20000
    buffer_load_dwordx4 v119, s[36:39], s50 offen lds
    s_add_u32 m0, m0, 0x400
    s_add_u32 s50, s50, 0x20000
    s_and_b32 s50, s50, 0x3fffff
    buffer_load_dwordx4 v119, s[36:39], s50 offen lds
    s_add_u32 m0, m0, 0x400
    s_add_u32 s50, s50, 0x20000
    buffer_load_dwordx4 v119, s[36:39], s50 offen lds
    s_add_u32 m0, m0, 0x400
    s_add_u32 s50, s50, 0x20000
    s_and_b32 s50, s50, 0x3fffff
    v_lshrrev_b32 v116, 4, v0
    v_and_b32 v117, 15, v0
    v_lshrrev_b32 v16, 2, v117
    v_and_b32 v17, 3, v117
    v_lshl_add_u32 v16, v16, 3, v17
    v_lshlrev_b32 v16, 13, v16
    v_lshl_add_u32 v14, v116, 4, v16
    v_add_u32 v15, 0x8000, v14
    s_lshl_b32 s53, s49, 20
    s_lshl_b32 s54, s33, 18
    s_add_u32 s53, s53, s54
    s_add_u32 s53, s53, s51
    s_mov_b32 s40, s10
    s_mov_b32 s41, s11
    s_add_u32 s40, s40, s53
    s_addc_u32 s41, s41, 0
    s_mov_b32 s42, 0x400000
    s_mov_b32 s43, 0x20000
    buffer_load_dwordx4 v[20:23], v14, s[40:43], 0 offen offset:0
    buffer_load_dwordx4 v[24:27], v14, s[40:43], 0 offen offset:64
    buffer_load_dwordx4 v[28:31], v14, s[40:43], 0 offen offset:128
    buffer_load_dwordx4 v[32:35], v14, s[40:43], 0 offen offset:192
    buffer_load_dwordx4 v[36:39], v15, s[40:43], 0 offen offset:0
    buffer_load_dwordx4 v[40:43], v15, s[40:43], 0 offen offset:64
    buffer_load_dwordx4 v[44:47], v15, s[40:43], 0 offen offset:128
    buffer_load_dwordx4 v[48:51], v15, s[40:43], 0 offen offset:192
    s_lshl_b32 s52, s48, 10
    s_lshl_b32 s53, s49, 8
    s_add_u32 s52, s52, s53
    v_lshlrev_b32 v12, 4, v117
    v_lshl_add_u32 v12, v116, 15, v12
    v_add_u32 v12, s52, v12
    v_and_b32 v164, 1, v0
    v_lshlrev_b32 v164, 7, v164
    s_lshl_b32 s51, s33, 11
    s_add_u32 s51, s51, 131072
    v_add_u32 v8, s51, v118
    v_lshrrev_b32 v16, 2, v117
    v_lshlrev_b32 v17, 11, v16
    v_lshl_add_u32 v17, v116, 4, v17
    s_lshl_b32 s51, s72, 8
    s_add_u32 s51, s51, 131072
    v_add_u32 v9, s51, v17
    v_lshl_add_u32 v16, v116, 3, v16
    v_lshlrev_b32 v16, 6, v16
    v_and_b32 v17, 1, v116
    v_lshl_add_u32 v16, v17, 5, v16
    v_and_b32 v17, 3, v117
    v_lshl_add_u32 v16, v17, 3, v16
    s_lshl_b32 s51, s33, 15
    v_add_u32 v120, s51, v16
    v_xor_b32 v121, 32, v120
    s_lshl_b32 s51, s33, 6
    s_add_u32 s52, s51, 139264
    v_lshlrev_b32 v16, 8, v116
    v_lshl_add_u32 v16, v117, 1, v16
    v_add_u32 v10, s52, v16
    v_and_b32 v17, 3, v117
    v_lshlrev_b32 v17, 8, v17
    v_lshl_add_u32 v17, v116, 4, v17
    v_add_u32 v11, 139264, v17
    s_add_u32 s52, s51, 143360
    v_lshlrev_b32 v16, 8, v117
    v_lshl_add_u32 v16, v116, 4, v16
    v_add_u32 v18, s52, v16
    v_add_u32 v19, 143360, v118
    s_mov_b32 s56, 0x000f000f
    s_mov_b32 s57, 0x000f000f
    s_mov_b32 s58, 0xfffefffe
    s_mov_b32 s59, 0x3e0293ee
    s_waitcnt vmcnt(12)
    s_mov_b32 s53, 0x3b000000
    v_lshlrev_b32 v52, 16, v4
    v_and_b32 v53, 0xffff0000, v4
    v_lshlrev_b32 v54, 16, v5
    v_and_b32 v55, 0xffff0000, v5
    v_lshlrev_b32 v56, 16, v6
    v_and_b32 v57, 0xffff0000, v6
    v_lshlrev_b32 v58, 16, v7
    v_and_b32 v59, 0xffff0000, v7
    buffer_load_dwordx4 v119, s[36:39], s50 offen lds
    s_add_u32 m0, m0, 0x400
    s_add_u32 s50, s50, 0x20000
    buffer_load_dwordx4 v119, s[36:39], s50 offen lds
    s_add_u32 m0, m0, 0x400
    s_add_u32 s50, s50, 0x20000
    s_and_b32 s50, s50, 0x3fffff
    v_readfirstlane_b32 s54, v52
    s_nop 1
    v_subrev_f32 v52, s54, v52
    v_subrev_f32 v53, s54, v53
    v_subrev_f32 v54, s54, v54
    v_subrev_f32 v55, s54, v55
    v_subrev_f32 v56, s54, v56
    v_subrev_f32 v57, s54, v57
    buffer_load_dwordx4 v119, s[36:39], s50 offen lds
    s_add_u32 m0, m0, 0x400
    s_add_u32 s50, s50, 0x20000
    buffer_load_dwordx4 v119, s[36:39], s50 offen lds
    s_add_u32 m0, m0, 0x400
    s_add_u32 s50, s50, 0x20000
    s_and_b32 s50, s50, 0x3fffff
    v_subrev_f32 v58, s54, v58
    v_subrev_f32 v59, s54, v59
    v_add_f32 v60, v52, v53
    v_add_f32 v61, v54, v55
    v_add_f32 v62, v56, v57
    v_add_f32 v63, v58, v59
    v_mul_f32 v64, v52, v52
    v_mul_f32 v65, v53, v53
    buffer_load_dwordx4 v119, s[36:39], s50 offen lds
    s_add_u32 m0, m0, 0x400
    s_add_u32 s50, s50, 0x20000
    buffer_load_dwordx4 v119, s[36:39], s50 offen lds
    s_add_u32 m0, m0, 0x400
    s_add_u32 s50, s50, 0x20000
    s_and_b32 s50, s50, 0x3fffff
    v_add_f32 v60, v60, v61
    v_add_f32 v62, v62, v63
    v_fmac_f32 v64, v54, v54
    v_fmac_f32 v65, v55, v55
    v_fmac_f32 v64, v56, v56
    v_fmac_f32 v65, v57, v57
    v_fmac_f32 v64, v58, v58
    v_fmac_f32 v65, v59, v59
    buffer_load_dwordx4 v119, s[36:39], s50 offen lds
    s_add_u32 m0, m0, 0x400
    s_add_u32 s50, s50, 0x20000
    buffer_load_dwordx4 v119, s[36:39], s50 offen lds
    s_add_u32 m0, m0, 0x400
    s_add_u32 s50, s50, 0x20000
    s_and_b32 s50, s50, 0x3fffff
    v_add_f32 v60, v60, v62
    v_add_f32 v61, v64, v65
    s_nop 0
    v_add_f32_dpp v60, v60, v60 quad_perm:[1,0,3,2] row_mask:0xf bank_mask:0xf
    v_add_f32_dpp v61, v61, v61 quad_perm:[1,0,3,2] row_mask:0xf bank_mask:0xf
    s_nop 0
    v_add_f32_dpp v60, v60, v60 quad_perm:[2,3,0,1] row_mask:0xf bank_mask:0xf
    v_add_f32_dpp v61, v61, v61 quad_perm:[2,3,0,1] row_mask:0xf bank_mask:0xf
    s_nop 0
    v_add_f32_dpp v60, v60, v60 row_half_mirror row_mask:0xf bank_mask:0xf
    v_add_f32_dpp v61, v61, v61 row_half_mirror row_mask:0xf bank_mask:0xf
    s_nop 0
    v_add_f32_dpp v60, v60, v60 row_mirror row_mask:0xf bank_mask:0xf
    v_add_f32_dpp v61, v61, v61 row_mirror row_mask:0xf bank_mask:0xf
    v_mov_b32 v62, v60
    v_mov_b32 v63, v61
    s_nop 0
    v_permlane16_swap_b32 v60, v62
    v_permlane16_swap_b32 v61, v63
    v_add_f32 v60, v60, v62
    v_add_f32 v61, v61, v63
    v_mov_b32 v62, v60
    v_mov_b32 v63, v61
    s_nop 0
    v_permlane32_swap_b32 v60, v62
    v_permlane32_swap_b32 v61, v63
    v_add_f32 v60, v60, v62
    v_add_f32 v61, v61, v63
    v_mul_f32 v60, 0x3b000000, v60
    v_mul_f32 v62, v60, v60
    v_fma_f32 v61, v61, s53, -v62
    v_max_f32 v61, 0, v61
    buffer_load_dwordx4 v119, s[36:39], s50 offen lds
    s_add_u32 m0, m0, 0x400
    s_add_u32 s50, s50, 0x20000
    buffer_load_dwordx4 v119, s[36:39], s50 offen lds
    s_add_u32 m0, m0, 0x400
    s_add_u32 s50, s50, 0x20000
    s_and_b32 s50, s50, 0x3fffff
    v_add_f32 v61, 0x3727c5ac, v61
    v_rsq_f32 v61, v61
    s_nop 0
    v_mul_f32 v60, v60, v61
    v_fma_f32 v52, v52, v61, -v60
    v_fma_f32 v53, v53, v61, -v60
    v_fma_f32 v54, v54, v61, -v60
    v_fma_f32 v55, v55, v61, -v60
    buffer_load_dwordx4 v119, s[36:39], s50 offen lds
    s_add_u32 m0, m0, 0x400
    s_add_u32 s50, s50, 0x20000
    buffer_load_dwordx4 v119, s[36:39], s50 offen lds
    s_add_u32 m0, m0, 0x400
    s_add_u32 s50, s50, 0x20000
    s_and_b32 s50, s50, 0x3fffff
    v_fma_f32 v56, v56, v61, -v60
    v_fma_f32 v57, v57, v61, -v60
    v_fma_f32 v58, v58, v61, -v60
    v_fma_f32 v59, v59, v61, -v60
    v_cvt_pk_bf16_f32 v4, v52, v53
    v_cvt_pk_bf16_f32 v5, v54, v55
    v_cvt_pk_bf16_f32 v6, v56, v57
    v_cvt_pk_bf16_f32 v7, v58, v59
    buffer_load_dwordx4 v119, s[36:39], s50 offen lds
    s_add_u32 m0, m0, 0x400
    s_add_u32 s50, s50, 0x20000
    buffer_load_dwordx4 v119, s[36:39], s50 offen lds
    s_add_u32 m0, m0, 0x400
    s_add_u32 s50, s50, 0x20000
    s_and_b32 s50, s50, 0x3fffff
    ds_write_b128 v8, v[4:7]
    ds_write_b128 v8, v[4:7] offset:1024
    s_waitcnt lgkmcnt(0)
    s_barrier
    ds_read_b128 v[52:55], v9 offset:0
    ds_read_b128 v[56:59], v9 offset:64
    ds_read_b128 v[60:63], v9 offset:128
    ds_read_b128 v[64:67], v9 offset:192
    buffer_load_dwordx4 v119, s[36:39], s50 offen lds
    s_add_u32 m0, m0, 0x400
    s_add_u32 s50, s50, 0x20000
    buffer_load_dwordx4 v119, s[36:39], s50 offen lds
    s_add_u32 m0, m0, 0x400
    s_add_u32 s50, s50, 0x20000
    s_and_b32 s50, s50, 0x3fffff
    ds_read_b128 v[68:71], v9 offset:256
    ds_read_b128 v[72:75], v9 offset:320
    ds_read_b128 v[76:79], v9 offset:384
    ds_read_b128 v[80:83], v9 offset:448
    buffer_load_dwordx4 v119, s[36:39], s50 offen lds
    s_add_u32 m0, m0, 0x400
    s_add_u32 s50, s50, 0x20000
    buffer_load_dwordx4 v119, s[36:39], s50 offen lds
    s_add_u32 m0, m0, 0x400
    s_add_u32 s50, s50, 0x20000
    s_and_b32 s50, s50, 0x3fffff
    ds_read_b128 v[84:87], v9 offset:512
    ds_read_b128 v[88:91], v9 offset:576
    ds_read_b128 v[92:95], v9 offset:640
    ds_read_b128 v[96:99], v9 offset:704
    buffer_load_dwordx4 v119, s[36:39], s50 offen lds
    s_add_u32 m0, m0, 0x400
    s_add_u32 s50, s50, 0x20000
    buffer_load_dwordx4 v119, s[36:39], s50 offen lds
    s_add_u32 m0, m0, 0x400
    s_add_u32 s50, s50, 0x20000
    s_and_b32 s50, s50, 0x3fffff
    ds_read_b128 v[100:103], v9 offset:768
    ds_read_b128 v[104:107], v9 offset:832
    ds_read_b128 v[108:111], v9 offset:896
    ds_read_b128 v[112:115], v9 offset:960
    buffer_load_dwordx4 v119, s[36:39], s50 offen lds
    s_add_u32 m0, m0, 0x400
    s_add_u32 s50, s50, 0x20000
    buffer_load_dwordx4 v119, s[36:39], s50 offen lds
    s_add_u32 m0, m0, 0x400
    s_add_u32 s50, s50, 0x20000
    s_and_b32 s50, s50, 0x3fffff
    buffer_load_dwordx4 v119, s[36:39], s50 offen lds
    s_add_u32 m0, m0, 0x400
    s_add_u32 s50, s50, 0x20000
    buffer_load_dwordx4 v119, s[36:39], s50 offen lds
    s_add_u32 m0, m0, 0x400
    s_add_u32 s50, s50, 0x20000
    s_and_b32 s50, s50, 0x3fffff
    buffer_load_dwordx4 v119, s[36:39], s50 offen lds
    s_add_u32 m0, m0, 0x400
    s_add_u32 s50, s50, 0x20000
    buffer_load_dwordx4 v119, s[36:39], s50 offen lds
    s_add_u32 m0, m0, 0x400
    s_add_u32 s50, s50, 0x20000
    s_and_b32 s50, s50, 0x3fffff
    buffer_load_dwordx4 v119, s[36:39], s50 offen lds
    s_add_u32 m0, m0, 0x400
    s_add_u32 s50, s50, 0x20000
    buffer_load_dwordx4 v119, s[36:39], s50 offen lds
    s_add_u32 m0, m0, 0x400
    s_add_u32 s50, s50, 0x20000
    s_and_b32 s50, s50, 0x3fffff
    global_load_dword v165, v164, s[26:27] sc1
    s_lshl_b32 s51, s48, 8
    s_lshl_b32 s52, s33, 6
    s_add_u32 s52, s52, s51
    s_mov_b32 s36, s12
    s_mov_b32 s37, s13
    s_add_u32 s36, s36, s52
    s_addc_u32 s37, s37, 0
    s_mov_b32 s38, 0x400000
    s_mov_b32 s39, 0x20000
    s_lshl_b32 m0, s33, 15
    s_lshl_b32 s50, s49, 20
    s_waitcnt vmcnt(37)
    ds_read_b64_tr_b16 v[132:133], v120 offset:0
    ds_read_b64_tr_b16 v[134:135], v120 offset:256
    ds_read_b64_tr_b16 v[136:137], v121 offset:0
    ds_read_b64_tr_b16 v[138:139], v121 offset:256
    ds_read_b64_tr_b16 v[140:141], v120 offset:2048
    ds_read_b64_tr_b16 v[142:143], v120 offset:2304
    ds_read_b64_tr_b16 v[144:145], v121 offset:2048
    ds_read_b64_tr_b16 v[146:147], v121 offset:2304
    s_waitcnt vmcnt(25)
    ds_read_b64_tr_b16 v[148:149], v120 offset:4096
    ds_read_b64_tr_b16 v[150:151], v120 offset:4352
    ds_read_b64_tr_b16 v[152:153], v121 offset:4096
    ds_read_b64_tr_b16 v[154:155], v121 offset:4352
    ds_read_b64_tr_b16 v[156:157], v120 offset:6144
    ds_read_b64_tr_b16 v[158:159], v120 offset:6400
    ds_read_b64_tr_b16 v[160:161], v121 offset:6144
    ds_read_b64_tr_b16 v[162:163], v121 offset:6400
    s_waitcnt lgkmcnt(8)
    v_mfma_f32_16x16x32_bf16 v[122:125], v[52:55], v[132:135], 0
    v_mfma_f32_16x16x32_bf16 v[126:129], v[52:55], v[136:139], 0
    v_mfma_f32_16x16x32_bf16 v[122:125], v[56:59], v[140:143], v[122:125]
    v_mfma_f32_16x16x32_bf16 v[126:129], v[56:59], v[144:147], v[126:129]
    s_waitcnt vmcnt(21)
    ds_read_b64_tr_b16 v[132:133], v120 offset:8192
    ds_read_b64_tr_b16 v[134:135], v120 offset:8448
    ds_read_b64_tr_b16 v[136:137], v121 offset:8192
    ds_read_b64_tr_b16 v[138:139], v121 offset:8448
    ds_read_b64_tr_b16 v[140:141], v120 offset:10240
    ds_read_b64_tr_b16 v[142:143], v120 offset:10496
    ds_read_b64_tr_b16 v[144:145], v121 offset:10240
    ds_read_b64_tr_b16 v[146:147], v121 offset:10496
    s_waitcnt lgkmcnt(8)
    v_mfma_f32_16x16x32_bf16 v[122:125], v[60:63], v[148:151], v[122:125]
    v_mfma_f32_16x16x32_bf16 v[126:129], v[60:63], v[152:155], v[126:129]
    v_mfma_f32_16x16x32_bf16 v[122:125], v[64:67], v[156:159], v[122:125]
    v_mfma_f32_16x16x32_bf16 v[126:129], v[64:67], v[160:163], v[126:129]
    s_waitcnt vmcnt(17)
    ds_read_b64_tr_b16 v[148:149], v120 offset:12288
    ds_read_b64_tr_b16 v[150:151], v120 offset:12544
    ds_read_b64_tr_b16 v[152:153], v121 offset:12288
    ds_read_b64_tr_b16 v[154:155], v121 offset:12544
    ds_read_b64_tr_b16 v[156:157], v120 offset:14336
    ds_read_b64_tr_b16 v[158:159], v120 offset:14592
    ds_read_b64_tr_b16 v[160:161], v121 offset:14336
    ds_read_b64_tr_b16 v[162:163], v121 offset:14592
    s_waitcnt lgkmcnt(8)
    v_mfma_f32_16x16x32_bf16 v[122:125], v[68:71], v[132:135], v[122:125]
    v_mfma_f32_16x16x32_bf16 v[126:129], v[68:71], v[136:139], v[126:129]
    v_mfma_f32_16x16x32_bf16 v[122:125], v[72:75], v[140:143], v[122:125]
    v_mfma_f32_16x16x32_bf16 v[126:129], v[72:75], v[144:147], v[126:129]
    s_waitcnt vmcnt(13)
    ds_read_b64_tr_b16 v[132:133], v120 offset:16384
    ds_read_b64_tr_b16 v[134:135], v120 offset:16640
    ds_read_b64_tr_b16 v[136:137], v121 offset:16384
    ds_read_b64_tr_b16 v[138:139], v121 offset:16640
    ds_read_b64_tr_b16 v[140:141], v120 offset:18432
    ds_read_b64_tr_b16 v[142:143], v120 offset:18688
    ds_read_b64_tr_b16 v[144:145], v121 offset:18432
    ds_read_b64_tr_b16 v[146:147], v121 offset:18688
    s_waitcnt lgkmcnt(8)
    v_mfma_f32_16x16x32_bf16 v[122:125], v[76:79], v[148:151], v[122:125]
    v_mfma_f32_16x16x32_bf16 v[126:129], v[76:79], v[152:155], v[126:129]
    v_mfma_f32_16x16x32_bf16 v[122:125], v[80:83], v[156:159], v[122:125]
    v_mfma_f32_16x16x32_bf16 v[126:129], v[80:83], v[160:163], v[126:129]
    s_waitcnt vmcnt(9)
    ds_read_b64_tr_b16 v[148:149], v120 offset:20480
    ds_read_b64_tr_b16 v[150:151], v120 offset:20736
    ds_read_b64_tr_b16 v[152:153], v121 offset:20480
    ds_read_b64_tr_b16 v[154:155], v121 offset:20736
    ds_read_b64_tr_b16 v[156:157], v120 offset:22528
    ds_read_b64_tr_b16 v[158:159], v120 offset:22784
    ds_read_b64_tr_b16 v[160:161], v121 offset:22528
    ds_read_b64_tr_b16 v[162:163], v121 offset:22784
    s_waitcnt lgkmcnt(8)
    v_mfma_f32_16x16x32_bf16 v[122:125], v[84:87], v[132:135], v[122:125]
    v_mfma_f32_16x16x32_bf16 v[126:129], v[84:87], v[136:139], v[126:129]
    v_mfma_f32_16x16x32_bf16 v[122:125], v[88:91], v[140:143], v[122:125]
    v_mfma_f32_16x16x32_bf16 v[126:129], v[88:91], v[144:147], v[126:129]
    s_waitcnt vmcnt(5)
    ds_read_b64_tr_b16 v[132:133], v120 offset:24576
    ds_read_b64_tr_b16 v[134:135], v120 offset:24832
    ds_read_b64_tr_b16 v[136:137], v121 offset:24576
    ds_read_b64_tr_b16 v[138:139], v121 offset:24832
    ds_read_b64_tr_b16 v[140:141], v120 offset:26624
    ds_read_b64_tr_b16 v[142:143], v120 offset:26880
    ds_read_b64_tr_b16 v[144:145], v121 offset:26624
    ds_read_b64_tr_b16 v[146:147], v121 offset:26880
    s_waitcnt lgkmcnt(8)
    v_mfma_f32_16x16x32_bf16 v[122:125], v[92:95], v[148:151], v[122:125]
    v_mfma_f32_16x16x32_bf16 v[126:129], v[92:95], v[152:155], v[126:129]
    v_mfma_f32_16x16x32_bf16 v[122:125], v[96:99], v[156:159], v[122:125]
    v_mfma_f32_16x16x32_bf16 v[126:129], v[96:99], v[160:163], v[126:129]
    s_waitcnt vmcnt(1)
    ds_read_b64_tr_b16 v[148:149], v120 offset:28672
    ds_read_b64_tr_b16 v[150:151], v120 offset:28928
    ds_read_b64_tr_b16 v[152:153], v121 offset:28672
    ds_read_b64_tr_b16 v[154:155], v121 offset:28928
    ds_read_b64_tr_b16 v[156:157], v120 offset:30720
    ds_read_b64_tr_b16 v[158:159], v120 offset:30976
    ds_read_b64_tr_b16 v[160:161], v121 offset:30720
    ds_read_b64_tr_b16 v[162:163], v121 offset:30976
    s_waitcnt lgkmcnt(8)
    v_mfma_f32_16x16x32_bf16 v[122:125], v[100:103], v[132:135], v[122:125]
    v_mfma_f32_16x16x32_bf16 v[126:129], v[100:103], v[136:139], v[126:129]
    v_mfma_f32_16x16x32_bf16 v[122:125], v[104:107], v[140:143], v[122:125]
    v_mfma_f32_16x16x32_bf16 v[126:129], v[104:107], v[144:147], v[126:129]
    s_waitcnt lgkmcnt(0)
    v_mfma_f32_16x16x32_bf16 v[122:125], v[108:111], v[148:151], v[122:125]
    v_mfma_f32_16x16x32_bf16 v[126:129], v[108:111], v[152:155], v[126:129]
    v_mfma_f32_16x16x32_bf16 v[122:125], v[112:115], v[156:159], v[122:125]
    v_mfma_f32_16x16x32_bf16 v[126:129], v[112:115], v[160:163], v[126:129]
    s_nop 7
    v_cvt_pk_bf16_f32 v130, v122, v122
    v_cvt_pk_bf16_f32 v131, v126, v126
    ds_write_b16 v10, v130
    ds_write_b16 v10, v131 offset:32
    s_waitcnt lgkmcnt(0)
    s_barrier
    ds_read_b128 v[52:55], v11 offset:0
    ds_read_b128 v[56:59], v11 offset:64
    ds_read_b128 v[60:63], v11 offset:128
    ds_read_b128 v[64:67], v11 offset:192
    s_waitcnt vmcnt(0)
L_W_go:
    v_cmp_gt_u32 vcc, 64, v165
    s_cbranch_vccz L_W_gook
    s_sleep 16
    s_add_u32 s55, s55, 1
    s_cmp_gt_u32 s55, 0x40000
    s_cbranch_scc1 L_fail
    global_load_dword v165, v164, s[26:27] sc1
    s_waitcnt vmcnt(0)
    s_branch L_W_go
L_W_gook:
    s_waitcnt lgkmcnt(3)
    v_mfma_f32_16x16x32_bf16 v[122:125], v[20:23], v[52:55], 0
    v_mfma_f32_16x16x32_bf16 v[126:129], v[36:39], v[52:55], 0
    s_waitcnt lgkmcnt(2)
    v_mfma_f32_16x16x32_bf16 v[122:125], v[24:27], v[56:59], v[122:125]
    v_mfma_f32_16x16x32_bf16 v[126:129], v[40:43], v[56:59], v[126:129]
    s_waitcnt lgkmcnt(1)
    v_mfma_f32_16x16x32_bf16 v[122:125], v[28:31], v[60:63], v[122:125]
    v_mfma_f32_16x16x32_bf16 v[126:129], v[44:47], v[60:63], v[126:129]
    s_waitcnt lgkmcnt(0)
    v_mfma_f32_16x16x32_bf16 v[122:125], v[32:35], v[64:67], v[122:125]
    v_mfma_f32_16x16x32_bf16 v[126:129], v[48:51], v[64:67], v[126:129]
    s_nop 6
    v_mul_f32 v122, s59, v122
    v_mul_f32 v123, s59, v123
    v_mul_f32 v124, s59, v124
    v_mul_f32 v125, s59, v125
    v_mul_f32 v126, s59, v126
    v_mul_f32 v127, s59, v127
    v_mul_f32 v128, s59, v128
    v_mul_f32 v129, s59, v129
    v_cvt_pk_bf16_f32 v132, v122, v123
    v_cvt_pk_bf16_f32 v133, v124, v125
    v_cvt_pk_bf16_f32 v134, v126, v127
    v_cvt_pk_bf16_f32 v135, v128, v129
    v_pk_min_u16 v132, v132, s58
    v_pk_min_u16 v133, v133, s58
    v_pk_min_u16 v134, v134, s58
    v_pk_min_u16 v135, v135, s58
    s_mov_b64 exec, s[56:57]
    ds_write_b128 v18, v[132:135]
    s_mov_b64 exec, -1
    s_waitcnt lgkmcnt(0)
    s_barrier
    s_cmp_lg_u32 s33, 0
    s_cbranch_scc1 L_W_noqa
    ds_read_b128 v[132:135], v19
    s_waitcnt lgkmcnt(0)
    global_store_dwordx4 v12, v[132:135], s[28:29] sc1
L_W_noqa:
    v_lshrrev_b32 v16, 4, v0
    v_bfe_u32 v17, v0, 1, 3
    v_xor_b32 v17, v17, v16
    v_lshlrev_b32 v17, 5, v17
    v_lshl_add_u32 v17, v16, 10, v17
    v_and_b32 v16, 1, v0
    v_lshl_add_u32 v150, v16, 4, v17
    v_xor_b32 v151, 128, v150
    v_lshrrev_b32 v16, 2, v117
    v_and_b32 v17, 1, v116
    v_lshl_or_b32 v17, v17, 2, v16
    v_lshlrev_b32 v17, 5, v17
    v_lshl_add_u32 v16, v116, 3, v16
    v_lshl_add_u32 v17, v16, 8, v17
    v_and_b32 v16, 3, v117
    v_lshl_add_u32 v17, v16, 3, v17
    s_lshl_b32 s51, s33, 15
    v_add_u32 v152, s51, v17
    v_xor_b32 v153, 32, v152
    v_xor_b32 v154, 64, v152
    v_xor_b32 v155, 96, v152
    v_xor_b32 v156, 128, v152
    v_xor_b32 v157, 160, v152
    v_xor_b32 v158, 192, v152
    v_xor_b32 v159, 224, v152
    s_lshl_b32 s51, s48, 17
    s_lshl_b32 s52, s33, 8
    s_add_u32 s51, s51, s52
    s_mov_b32 s40, s14
    s_mov_b32 s41, s15
    s_add_u32 s40, s40, s51
    s_addc_u32 s41, s41, 0
    s_mov_b32 s42, 0x20000
    s_mov_b32 s43, 0x20000
    s_lshl_b32 s60, s49, 15
    buffer_load_dwordx4 v119, s[36:39], s50 offen lds
    s_add_u32 m0, m0, 0x400
    s_add_u32 s50, s50, 0x20000
    buffer_load_dwordx4 v119, s[36:39], s50 offen lds
    s_add_u32 m0, m0, 0x400
    s_add_u32 s50, s50, 0x20000
    s_and_b32 s50, s50, 0x3fffff
    buffer_load_dwordx4 v119, s[36:39], s50 offen lds
    s_add_u32 m0, m0, 0x400
    s_add_u32 s50, s50, 0x20000
    buffer_load_dwordx4 v119, s[36:39], s50 offen lds
    s_add_u32 m0, m0, 0x400
    s_add_u32 s50, s50, 0x20000
    s_and_b32 s50, s50, 0x3fffff
    buffer_load_dwordx4 v119, s[36:39], s50 offen lds
    s_add_u32 m0, m0, 0x400
    s_add_u32 s50, s50, 0x20000
    buffer_load_dwordx4 v119, s[36:39], s50 offen lds
    s_add_u32 m0, m0, 0x400
    s_add_u32 s50, s50, 0x20000
    s_and_b32 s50, s50, 0x3fffff
    buffer_load_dwordx4 v119, s[36:39], s50 offen lds
    s_add_u32 m0, m0, 0x400
    s_add_u32 s50, s50, 0x20000
    buffer_load_dwordx4 v119, s[36:39], s50 offen lds
    s_add_u32 m0, m0, 0x400
    s_add_u32 s50, s50, 0x20000
    s_and_b32 s50, s50, 0x3fffff
    buffer_load_dwordx4 v119, s[36:39], s50 offen lds
    s_add_u32 m0, m0, 0x400
    s_add_u32 s50, s50, 0x20000
    buffer_load_dwordx4 v119, s[36:39], s50 offen lds
    s_add_u32 m0, m0, 0x400
    s_add_u32 s50, s50, 0x20000
    s_and_b32 s50, s50, 0x3fffff
    buffer_load_dwordx4 v119, s[36:39], s50 offen lds
    s_add_u32 m0, m0, 0x400
    s_add_u32 s50, s50, 0x20000
    buffer_load_dwordx4 v119, s[36:39], s50 offen lds
    s_add_u32 m0, m0, 0x400
    s_add_u32 s50, s50, 0x20000
    s_and_b32 s50, s50, 0x3fffff
    buffer_load_dwordx4 v119, s[36:39], s50 offen lds
    s_add_u32 m0, m0, 0x400
    s_add_u32 s50, s50, 0x20000
    buffer_load_dwordx4 v119, s[36:39], s50 offen lds
    s_add_u32 m0, m0, 0x400
    s_add_u32 s50, s50, 0x20000
    s_and_b32 s50, s50, 0x3fffff
    buffer_load_dwordx4 v119, s[36:39], s50 offen lds
    s_add_u32 m0, m0, 0x400
    s_add_u32 s50, s50, 0x20000
    buffer_load_dwordx4 v119, s[36:39], s50 offen lds
    s_add_u32 m0, m0, 0x400
    s_add_u32 s50, s50, 0x20000
    s_and_b32 s50, s50, 0x3fffff
    s_waitcnt vmcnt(14)
    ds_read_b64_tr_b16 a[0:1], v120 offset:0
    ds_read_b64_tr_b16 a[2:3], v120 offset:256
    ds_read_b64_tr_b16 a[64:65], v121 offset:0
    ds_read_b64_tr_b16 a[66:67], v121 offset:256
    buffer_load_dwordx4 v119, s[36:39], s50 offen lds
    s_add_u32 m0, m0, 0x400
    s_add_u32 s50, s50, 0x20000
    buffer_load_dwordx4 v119, s[36:39], s50 offen lds
    s_add_u32 m0, m0, 0x400
    s_add_u32 s50, s50, 0x20000
    s_and_b32 s50, s50, 0x3fffff
    s_waitcnt vmcnt(14)
    ds_read_b64_tr_b16 a[4:5], v120 offset:2048
    ds_read_b64_tr_b16 a[6:7], v120 offset:2304
    ds_read_b64_tr_b16 a[68:69], v121 offset:2048
    ds_read_b64_tr_b16 a[70:71], v121 offset:2304
    buffer_load_dwordx4 v119, s[36:39], s50 offen lds
    s_add_u32 m0, m0, 0x400
    s_add_u32 s50, s50, 0x20000
    buffer_load_dwordx4 v119, s[36:39], s50 offen lds
    s_add_u32 m0, m0, 0x400
    s_add_u32 s50, s50, 0x20000
    s_and_b32 s50, s50, 0x3fffff
    s_waitcnt vmcnt(14)
    ds_read_b64_tr_b16 a[8:9], v120 offset:4096
    ds_read_b64_tr_b16 a[10:11], v120 offset:4352
    ds_read_b64_tr_b16 a[72:73], v121 offset:4096
    ds_read_b64_tr_b16 a[74:75], v121 offset:4352
    buffer_load_dwordx4 v119, s[36:39], s50 offen lds
    s_add_u32 m0, m0, 0x400
    s_add_u32 s50, s50, 0x20000
    buffer_load_dwordx4 v119, s[36:39], s50 offen lds
    s_add_u32 m0, m0, 0x400
    s_add_u32 s50, s50, 0x20000
    s_and_b32 s50, s50, 0x3fffff
    s_waitcnt vmcnt(14)
    ds_read_b64_tr_b16 a[12:13], v120 offset:6144
    ds_read_b64_tr_b16 a[14:15], v120 offset:6400
    ds_read_b64_tr_b16 a[76:77], v121 offset:6144
    ds_read_b64_tr_b16 a[78:79], v121 offset:6400
    buffer_load_dwordx4 v119, s[36:39], s50 offen lds
    s_add_u32 m0, m0, 0x400
    s_add_u32 s50, s50, 0x20000
    buffer_load_dwordx4 v119, s[36:39], s50 offen lds
    s_add_u32 m0, m0, 0x400
    s_add_u32 s50, s50, 0x20000
    s_and_b32 s50, s50, 0x3fffff
    s_waitcnt vmcnt(14)
    ds_read_b64_tr_b16 a[16:17], v120 offset:8192
    ds_read_b64_tr_b16 a[18:19], v120 offset:8448
    ds_read_b64_tr_b16 a[80:81], v121 offset:8192
    ds_read_b64_tr_b16 a[82:83], v121 offset:8448
    buffer_load_dwordx4 v119, s[36:39], s50 offen lds
    s_add_u32 m0, m0, 0x400
    s_add_u32 s50, s50, 0x20000
    buffer_load_dwordx4 v119, s[36:39], s50 offen lds
    s_add_u32 m0, m0, 0x400
    s_add_u32 s50, s50, 0x20000
    s_and_b32 s50, s50, 0x3fffff
    s_waitcnt vmcnt(14)
    ds_read_b64_tr_b16 a[20:21], v120 offset:10240
    ds_read_b64_tr_b16 a[22:23], v120 offset:10496
    ds_read_b64_tr_b16 a[84:85], v121 offset:10240
    ds_read_b64_tr_b16 a[86:87], v121 offset:10496
    buffer_load_dwordx4 v119, s[36:39], s50 offen lds
    s_add_u32 m0, m0, 0x400
    s_add_u32 s50, s50, 0x20000
    buffer_load_dwordx4 v119, s[36:39], s50 offen lds
    s_add_u32 m0, m0, 0x400
    s_add_u32 s50, s50, 0x20000
    s_and_b32 s50, s50, 0x3fffff
    s_waitcnt vmcnt(14)
    ds_read_b64_tr_b16 a[24:25], v120 offset:12288
    ds_read_b64_tr_b16 a[26:27], v120 offset:12544
    ds_read_b64_tr_b16 a[88:89], v121 offset:12288
    ds_read_b64_tr_b16 a[90:91], v121 offset:12544
    buffer_load_dwordx4 v119, s[36:39], s50 offen lds
    s_add_u32 m0, m0, 0x400
    s_add_u32 s50, s50, 0x20000
    buffer_load_dwordx4 v119, s[36:39], s50 offen lds
    s_add_u32 m0, m0, 0x400
    s_add_u32 s50, s50, 0x20000
    s_and_b32 s50, s50, 0x3fffff
    s_waitcnt vmcnt(14)
    ds_read_b64_tr_b16 a[28:29], v120 offset:14336
    ds_read_b64_tr_b16 a[30:31], v120 offset:14592
    ds_read_b64_tr_b16 a[92:93], v121 offset:14336
    ds_read_b64_tr_b16 a[94:95], v121 offset:14592
    buffer_load_dwordx4 v119, s[36:39], s50 offen lds
    s_add_u32 m0, m0, 0x400
    s_add_u32 s50, s50, 0x20000
    buffer_load_dwordx4 v119, s[36:39], s50 offen lds
    s_add_u32 m0, m0, 0x400
    s_add_u32 s50, s50, 0x20000
    s_and_b32 s50, s50, 0x3fffff
    s_waitcnt vmcnt(14)
    ds_read_b64_tr_b16 a[32:33], v120 offset:16384
    ds_read_b64_tr_b16 a[34:35], v120 offset:16640
    ds_read_b64_tr_b16 a[96:97], v121 offset:16384
    ds_read_b64_tr_b16 a[98:99], v121 offset:16640
    s_waitcnt lgkmcnt(0)
    s_lshl_b32 m0, s33, 15
    s_nop 0
    buffer_load_dwordx4 v150, s[40:43], s60 offen lds
    s_add_u32 m0, m0, 0x400
    s_add_u32 s60, s60, 0x1000
    s_and_b32 s60, s60, 0x1ffff
    buffer_load_dwordx4 v150, s[40:43], s60 offen lds
    s_add_u32 m0, m0, 0x400
    s_add_u32 s60, s60, 0x1000
    s_and_b32 s60, s60, 0x1ffff
    s_waitcnt vmcnt(14)
    ds_read_b64_tr_b16 a[36:37], v120 offset:18432
    ds_read_b64_tr_b16 a[38:39], v120 offset:18688
    ds_read_b64_tr_b16 a[100:101], v121 offset:18432
    ds_read_b64_tr_b16 a[102:103], v121 offset:18688
    s_waitcnt lgkmcnt(0)
    buffer_load_dwordx4 v151, s[40:43], s60 offen lds
    s_add_u32 m0, m0, 0x400
    s_add_u32 s60, s60, 0x1000
    s_and_b32 s60, s60, 0x1ffff
    buffer_load_dwordx4 v151, s[40:43], s60 offen lds
    s_add_u32 m0, m0, 0x400
    s_add_u32 s60, s60, 0x1000
    s_and_b32 s60, s60, 0x1ffff
    s_waitcnt vmcnt(14)
    ds_read_b64_tr_b16 a[40:41], v120 offset:20480
    ds_read_b64_tr_b16 a[42:43], v120 offset:20736
    ds_read_b64_tr_b16 a[104:105], v121 offset:20480
    ds_read_b64_tr_b16 a[106:107], v121 offset:20736
    s_waitcnt lgkmcnt(0)
    buffer_load_dwordx4 v150, s[40:43], s60 offen lds
    s_add_u32 m0, m0, 0x400
    s_add_u32 s60, s60, 0x1000
    s_and_b32 s60, s60, 0x1ffff
    buffer_load_dwordx4 v150, s[40:43], s60 offen lds
    s_add_u32 m0, m0, 0x400
    s_add_u32 s60, s60, 0x1000
    s_and_b32 s60, s60, 0x1ffff
    s_waitcnt vmcnt(14)
    ds_read_b64_tr_b16 a[44:45], v120 offset:22528
    ds_read_b64_tr_b16 a[46:47], v120 offset:22784
    ds_read_b64_tr_b16 a[108:109], v121 offset:22528
    ds_read_b64_tr_b16 a[110:111], v121 offset:22784
    s_waitcnt lgkmcnt(0)
    buffer_load_dwordx4 v151, s[40:43], s60 offen lds
    s_add_u32 m0, m0, 0x400
    s_add_u32 s60, s60, 0x1000
    s_and_b32 s60, s60, 0x1ffff
    buffer_load_dwordx4 v151, s[40:43], s60 offen lds
    s_add_u32 m0, m0, 0x400
    s_add_u32 s60, s60, 0x1000
    s_and_b32 s60, s60, 0x1ffff
    s_waitcnt vmcnt(14)
    ds_read_b64_tr_b16 a[48:49], v120 offset:24576
    ds_read_b64_tr_b16 a[50:51], v120 offset:24832
    ds_read_b64_tr_b16 a[112:113], v121 offset:24576
    ds_read_b64_tr_b16 a[114:115], v121 offset:24832
    s_waitcnt lgkmcnt(0)
    buffer_load_dwordx4 v150, s[40:43], s60 offen lds
    s_add_u32 m0, m0, 0x400
    s_add_u32 s60, s60, 0x1000
    s_and_b32 s60, s60, 0x1ffff
    buffer_load_dwordx4 v150, s[40:43], s60 offen lds
    s_add_u32 m0, m0, 0x400
    s_add_u32 s60, s60, 0x1000
    s_and_b32 s60, s60, 0x1ffff
    s_waitcnt vmcnt(14)
    ds_read_b64_tr_b16 a[52:53], v120 offset:26624
    ds_read_b64_tr_b16 a[54:55], v120 offset:26880
    ds_read_b64_tr_b16 a[116:117], v121 offset:26624
    ds_read_b64_tr_b16 a[118:119], v121 offset:26880
    s_waitcnt lgkmcnt(0)
    buffer_load_dwordx4 v151, s[40:43], s60 offen lds
    s_add_u32 m0, m0, 0x400
    s_add_u32 s60, s60, 0x1000
    s_and_b32 s60, s60, 0x1ffff
    buffer_load_dwordx4 v151, s[40:43], s60 offen lds
    s_add_u32 m0, m0, 0x400
    s_add_u32 s60, s60, 0x1000
    s_and_b32 s60, s60, 0x1ffff
    s_waitcnt vmcnt(14)
    ds_read_b64_tr_b16 a[56:57], v120 offset:28672
    ds_read_b64_tr_b16 a[58:59], v120 offset:28928
    ds_read_b64_tr_b16 a[120:121], v121 offset:28672
    ds_read_b64_tr_b16 a[122:123], v121 offset:28928
    s_waitcnt lgkmcnt(0)
    buffer_load_dwordx4 v150, s[40:43], s60 offen lds
    s_add_u32 m0, m0, 0x400
    s_add_u32 s60, s60, 0x1000
    s_and_b32 s60, s60, 0x1ffff
    buffer_load_dwordx4 v150, s[40:43], s60 offen lds
    s_add_u32 m0, m0, 0x400
    s_add_u32 s60, s60, 0x1000
    s_and_b32 s60, s60, 0x1ffff
    s_waitcnt vmcnt(14)
    ds_read_b64_tr_b16 a[60:61], v120 offset:30720
    ds_read_b64_tr_b16 a[62:63], v120 offset:30976
    ds_read_b64_tr_b16 a[124:125], v121 offset:30720
    ds_read_b64_tr_b16 a[126:127], v121 offset:30976
    s_waitcnt lgkmcnt(0)
    buffer_load_dwordx4 v151, s[40:43], s60 offen lds
    s_add_u32 m0, m0, 0x400
    s_add_u32 s60, s60, 0x1000
    s_and_b32 s60, s60, 0x1ffff
    buffer_load_dwordx4 v151, s[40:43], s60 offen lds
    s_add_u32 m0, m0, 0x400
    s_add_u32 s60, s60, 0x1000
    s_and_b32 s60, s60, 0x1ffff
    s_waitcnt vmcnt(14)
    s_waitcnt lgkmcnt(0)
    buffer_load_dwordx4 v150, s[40:43], s60 offen lds
    s_add_u32 m0, m0, 0x400
    s_add_u32 s60, s60, 0x1000
    s_and_b32 s60, s60, 0x1ffff
    buffer_load_dwordx4 v150, s[40:43], s60 offen lds
    s_add_u32 m0, m0, 0x400
    s_add_u32 s60, s60, 0x1000
    s_and_b32 s60, s60, 0x1ffff
    s_waitcnt vmcnt(14)
    s_waitcnt lgkmcnt(0)
    buffer_load_dwordx4 v151, s[40:43], s60 offen lds
    s_add_u32 m0, m0, 0x400
    s_add_u32 s60, s60, 0x1000
    s_and_b32 s60, s60, 0x1ffff
    buffer_load_dwordx4 v151, s[40:43], s60 offen lds
    s_add_u32 m0, m0, 0x400
    s_add_u32 s60, s60, 0x1000
    s_and_b32 s60, s60, 0x1ffff
    s_waitcnt vmcnt(14)
    s_waitcnt lgkmcnt(0)
    buffer_load_dwordx4 v150, s[40:43], s60 offen lds
    s_add_u32 m0, m0, 0x400
    s_add_u32 s60, s60, 0x1000
    s_and_b32 s60, s60, 0x1ffff
    buffer_load_dwordx4 v150, s[40:43], s60 offen lds
    s_add_u32 m0, m0, 0x400
    s_add_u32 s60, s60, 0x1000
    s_and_b32 s60, s60, 0x1ffff
    s_waitcnt vmcnt(14)
    ds_read_b64_tr_b16 a[128:129], v152 offset:0
    ds_read_b64_tr_b16 a[130:131], v152 offset:1024
    ds_read_b64_tr_b16 a[144:145], v153 offset:0
    ds_read_b64_tr_b16 a[146:147], v153 offset:1024
    ds_read_b64_tr_b16 a[160:161], v154 offset:0
    ds_read_b64_tr_b16 a[162:163], v154 offset:1024
    ds_read_b64_tr_b16 a[176:177], v155 offset:0
    ds_read_b64_tr_b16 a[178:179], v155 offset:1024
    ds_read_b64_tr_b16 a[192:193], v156 offset:0
    ds_read_b64_tr_b16 a[194:195], v156 offset:1024
    ds_read_b64_tr_b16 a[208:209], v157 offset:0
    ds_read_b64_tr_b16 a[210:211], v157 offset:1024
    ds_read_b64_tr_b16 a[224:225], v158 offset:0
    ds_read_b64_tr_b16 a[226:227], v158 offset:1024
    ds_read_b64_tr_b16 a[240:241], v159 offset:0
    ds_read_b64_tr_b16 a[242:243], v159 offset:1024
    s_waitcnt lgkmcnt(0)
    buffer_load_dwordx4 v151, s[40:43], s60 offen lds
    s_add_u32 m0, m0, 0x400
    s_add_u32 s60, s60, 0x1000
    s_and_b32 s60, s60, 0x1ffff
    buffer_load_dwordx4 v151, s[40:43], s60 offen lds
    s_add_u32 m0, m0, 0x400
    s_add_u32 s60, s60, 0x1000
    s_and_b32 s60, s60, 0x1ffff
    s_waitcnt vmcnt(14)
    s_waitcnt lgkmcnt(0)
    buffer_load_dwordx4 v150, s[40:43], s60 offen lds
    s_add_u32 m0, m0, 0x400
    s_add_u32 s60, s60, 0x1000
    s_and_b32 s60, s60, 0x1ffff
    buffer_load_dwordx4 v150, s[40:43], s60 offen lds
    s_add_u32 m0, m0, 0x400
    s_add_u32 s60, s60, 0x1000
    s_and_b32 s60, s60, 0x1ffff
    s_waitcnt vmcnt(14)
    s_waitcnt lgkmcnt(0)
    buffer_load_dwordx4 v151, s[40:43], s60 offen lds
    s_add_u32 m0, m0, 0x400
    s_add_u32 s60, s60, 0x1000
    s_and_b32 s60, s60, 0x1ffff
    buffer_load_dwordx4 v151, s[40:43], s60 offen lds
    s_add_u32 m0, m0, 0x400
    s_add_u32 s60, s60, 0x1000
    s_and_b32 s60, s60, 0x1ffff
    s_waitcnt vmcnt(14)
    s_waitcnt lgkmcnt(0)
    buffer_load_dwordx4 v150, s[40:43], s60 offen lds
    s_add_u32 m0, m0, 0x400
    s_add_u32 s60, s60, 0x1000
    s_and_b32 s60, s60, 0x1ffff
    buffer_load_dwordx4 v150, s[40:43], s60 offen lds
    s_add_u32 m0, m0, 0x400
    s_add_u32 s60, s60, 0x1000
    s_and_b32 s60, s60, 0x1ffff
    s_waitcnt vmcnt(14)
    ds_read_b64_tr_b16 a[132:133], v152 offset:8192
    ds_read_b64_tr_b16 a[134:135], v152 offset:9216
    ds_read_b64_tr_b16 a[148:149], v153 offset:8192
    ds_read_b64_tr_b16 a[150:151], v153 offset:9216
    ds_read_b64_tr_b16 a[164:165], v154 offset:8192
    ds_read_b64_tr_b16 a[166:167], v154 offset:9216
    ds_read_b64_tr_b16 a[180:181], v155 offset:8192
    ds_read_b64_tr_b16 a[182:183], v155 offset:9216
    ds_read_b64_tr_b16 a[196:197], v156 offset:8192
    ds_read_b64_tr_b16 a[198:199], v156 offset:9216
    ds_read_b64_tr_b16 a[212:213], v157 offset:8192
    ds_read_b64_tr_b16 a[214:215], v157 offset:9216
    ds_read_b64_tr_b16 a[228:229], v158 offset:8192
    ds_read_b64_tr_b16 a[230:231], v158 offset:9216
    ds_read_b64_tr_b16 a[244:245], v159 offset:8192
    ds_read_b64_tr_b16 a[246:247], v159 offset:9216
    s_waitcnt lgkmcnt(0)
    buffer_load_dwordx4 v151, s[40:43], s60 offen lds
    s_add_u32 m0, m0, 0x400
    s_add_u32 s60, s60, 0x1000
    s_and_b32 s60, s60, 0x1ffff
    buffer_load_dwordx4 v151, s[40:43], s60 offen lds
    s_add_u32 m0, m0, 0x400
    s_add_u32 s60, s60, 0x1000
    s_and_b32 s60, s60, 0x1ffff
    s_waitcnt vmcnt(14)
    s_waitcnt vmcnt(12)
    s_waitcnt vmcnt(10)
    s_waitcnt vmcnt(8)
    ds_read_b64_tr_b16 a[136:137], v152 offset:16384
    ds_read_b64_tr_b16 a[138:139], v152 offset:17408
    ds_read_b64_tr_b16 a[152:153], v153 offset:16384
    ds_read_b64_tr_b16 a[154:155], v153 offset:17408
    ds_read_b64_tr_b16 a[168:169], v154 offset:16384
    ds_read_b64_tr_b16 a[170:171], v154 offset:17408
    ds_read_b64_tr_b16 a[184:185], v155 offset:16384
    ds_read_b64_tr_b16 a[186:187], v155 offset:17408
    ds_read_b64_tr_b16 a[200:201], v156 offset:16384
    ds_read_b64_tr_b16 a[202:203], v156 offset:17408
    ds_read_b64_tr_b16 a[216:217], v157 offset:16384
    ds_read_b64_tr_b16 a[218:219], v157 offset:17408
    ds_read_b64_tr_b16 a[232:233], v158 offset:16384
    ds_read_b64_tr_b16 a[234:235], v158 offset:17408
    ds_read_b64_tr_b16 a[248:249], v159 offset:16384
    ds_read_b64_tr_b16 a[250:251], v159 offset:17408
    s_waitcnt vmcnt(6)
    s_waitcnt vmcnt(4)
    s_waitcnt vmcnt(2)
    s_waitcnt vmcnt(0)
    ds_read_b64_tr_b16 a[140:141], v152 offset:24576
    ds_read_b64_tr_b16 a[142:143], v152 offset:25600
    ds_read_b64_tr_b16 a[156:157], v153 offset:24576
    ds_read_b64_tr_b16 a[158:159], v153 offset:25600
    ds_read_b64_tr_b16 a[172:173], v154 offset:24576
    ds_read_b64_tr_b16 a[174:175], v154 offset:25600
    ds_read_b64_tr_b16 a[188:189], v155 offset:24576
    ds_read_b64_tr_b16 a[190:191], v155 offset:25600
    ds_read_b64_tr_b16 a[204:205], v156 offset:24576
    ds_read_b64_tr_b16 a[206:207], v156 offset:25600
    ds_read_b64_tr_b16 a[220:221], v157 offset:24576
    ds_read_b64_tr_b16 a[222:223], v157 offset:25600
    ds_read_b64_tr_b16 a[236:237], v158 offset:24576
    ds_read_b64_tr_b16 a[238:239], v158 offset:25600
    ds_read_b64_tr_b16 a[252:253], v159 offset:24576
    ds_read_b64_tr_b16 a[254:255], v159 offset:25600
    s_lshl_b32 s51, s49, 5
    s_add_u32 s51, s51, s48
    s_lshl_b32 s52, s49, 13
    s_lshl_b32 s53, s48, 3
    s_add_u32 s52, s52, s53
    s_add_u32 s52, s52, 0x20000
    v_and_b32 v16, 31, v0
    v_lshlrev_b32 v16, 8, v16
    v_add_u32 v16, s52, v16
    s_lshl_b32 s52, s33, 6
    s_add_u32 s52, s52, 144384
    v_and_b32 v142, 31, v0
    v_lshlrev_b32 v142, 1, v142
    v_add_u32 v142, s52, v142
    v_lshlrev_b32 v141, 4, v116
    v_add_u32 v141, s52, v141
    s_lshl_b32 s52, s51, 15
    s_lshl_b32 s53, s33, 8
    s_add_u32 s52, s52, s53
    s_mov_b32 s44, s28
    s_mov_b32 s45, s29
    s_add_u32 s44, s44, s52
    s_addc_u32 s45, s45, 0
    s_add_u32 s44, s44, 0x100000
    s_addc_u32 s45, s45, 0
    s_mov_b32 s46, 0x8000
    s_mov_b32 s47, 0x20000
    s_lshl_b32 s52, s51, 10
    s_add_u32 s52, s52, s53
    s_add_u32 s52, s52, 0x30000
    v_and_b32 v17, 1, v0
    v_mul_u32_u24 v17, 126, v17
    v_lshl_add_u32 v17, v0, 1, v17
    v_add_u32 v149, s52, v17
    v_bfe_u32 v17, v0, 1, 1
    v_mul_u32_u24 v19, 1088, v17
    v_lshrrev_b32 v18, 2, v0
    v_lshl_add_u32 v19, v18, 2, v19
    v_and_b32 v18, 1, v0
    v_lshl_add_u32 v19, v18, 1, v19
    s_lshl_b32 s52, s33, 7
    s_add_u32 s52, s52, 140288
    v_add_u32 v148, s52, v19
    v_mul_u32_u24 v19, 320, v17
    v_bfe_u32 v17, v0, 2, 3
    v_lshl_add_u32 v19, v17, 2, v19
    v_lshl_add_u32 v19, v18, 1, v19
    s_lshl_b32 s52, s33, 5
    s_add_u32 s52, s52, 142592
    v_add_u32 v145, s52, v19
    v_mul_u32_u24 v19, 1088, v18
    v_lshl_add_u32 v19, v116, 4, v19
    s_lshl_b32 s52, s73, 7
    s_add_u32 s52, s52, 140288
    v_add_u32 v147, s52, v19
    v_mul_u32_u24 v19, 320, v18
    v_lshl_add_u32 v19, v116, 4, v19
    s_lshl_b32 s52, s74, 5
    s_add_u32 s52, s52, 142592
    v_add_u32 v146, s52, v19
    v_mov_b32 v140, 0x4444
    v_mov_b32 v19, 0xeeee
    v_cmp_eq_u32 vcc, 1, v18
    s_nop 1
    v_cndmask_b32 v140, v140, v19, vcc
    v_mov_b32 v224, 0
    v_mov_b32 v225, 0
    v_mov_b32 v226, 0
    v_mov_b32 v227, 0
    v_mov_b32 v228, 0
    v_mov_b32 v229, 0
    v_mov_b32 v230, 0
    v_mov_b32 v231, 0
    v_mov_b32 v20, 0
    v_mov_b32 v21, 0
    v_mov_b32 v22, 0
    v_mov_b32 v23, 0
    v_mov_b32 v24, 0
    v_mov_b32 v25, 0
    v_mov_b32 v26, 0
    v_mov_b32 v27, 0
    v_mov_b32 v28, 0
    v_mov_b32 v29, 0
    v_mov_b32 v30, 0
    v_mov_b32 v31, 0
    v_mov_b32 v32, 0
    v_mov_b32 v33, 0
    v_mov_b32 v34, 0
    v_mov_b32 v35, 0
    v_mov_b32 v36, 0
    v_mov_b32 v37, 0
    v_mov_b32 v38, 0
    v_mov_b32 v39, 0
    v_mov_b32 v40, 0
    v_mov_b32 v41, 0
    v_mov_b32 v42, 0
    v_mov_b32 v43, 0
    v_mov_b32 v44, 0
    v_mov_b32 v45, 0
    v_mov_b32 v46, 0
    v_mov_b32 v47, 0
    v_mov_b32 v48, 0
    v_mov_b32 v49, 0
    v_mov_b32 v50, 0
    v_mov_b32 v51, 0
    s_mov_b32 s56, 0xaaaaaaaa
    s_mov_b32 s57, 0xaaaaaaaa
    s_waitcnt lgkmcnt(0)
L_W_ml:
    global_load_dwordx2 v[160:161], v16, s[28:29] sc1
    s_waitcnt vmcnt(0)
    v_max_u32 v18, v160, v161
    v_cmp_eq_u32 vcc, -1, v18
    s_cbranch_vccz L_W_mlok
    s_sleep 8
    s_add_u32 s55, s55, 1
    s_cmp_gt_u32 s55, 0x40000
    s_cbranch_scc1 L_fail
    s_branch L_W_ml
L_W_mlok:
    s_lshl_b32 m0, s33, 15
    s_mov_b32 s50, 0
    buffer_load_dwordx4 v150, s[44:47], s50 offen sc1 lds
    s_add_u32 m0, m0, 0x400
    s_add_u32 s50, s50, 0x1000
    buffer_load_dwordx4 v150, s[44:47], s50 offen sc1 lds
    s_add_u32 m0, m0, 0x400
    s_add_u32 s50, s50, 0x1000
    buffer_load_dwordx4 v151, s[44:47], s50 offen sc1 lds
    s_add_u32 m0, m0, 0x400
    s_add_u32 s50, s50, 0x1000
    buffer_load_dwordx4 v151, s[44:47], s50 offen sc1 lds
    s_add_u32 m0, m0, 0x400
    s_add_u32 s50, s50, 0x1000
    buffer_load_dwordx4 v150, s[44:47], s50 offen sc1 lds
    s_add_u32 m0, m0, 0x400
    s_add_u32 s50, s50, 0x1000
    buffer_load_dwordx4 v150, s[44:47], s50 offen sc1 lds
    s_add_u32 m0, m0, 0x400
    s_add_u32 s50, s50, 0x1000
    buffer_load_dwordx4 v151, s[44:47], s50 offen sc1 lds
    s_add_u32 m0, m0, 0x400
    s_add_u32 s50, s50, 0x1000
    buffer_load_dwordx4 v151, s[44:47], s50 offen sc1 lds
    v_mov_b32 v18, v160
    s_nop 1
    v_max_f32_dpp v18, v18, v18 quad_perm:[1,0,3,2] row_mask:0xf bank_mask:0xf
    s_nop 1
    v_max_f32_dpp v18, v18, v18 quad_perm:[2,3,0,1] row_mask:0xf bank_mask:0xf
    s_nop 1
    v_max_f32_dpp v18, v18, v18 row_half_mirror row_mask:0xf bank_mask:0xf
    s_nop 1
    v_max_f32_dpp v18, v18, v18 row_mirror row_mask:0xf bank_mask:0xf
    v_mov_b32 v19, v18
    s_nop 1
    v_permlane16_swap_b32 v18, v19
    v_max_f32 v18, v18, v19
    v_sub_f32 v176, v160, v18
    v_exp_f32 v176, v176
    s_nop 0
    v_cvt_pk_bf16_f32 v19, v176, v176
    ds_write_b16 v142, v19
    v_mul_f32 v18, v176, v161
    s_nop 1
    v_add_f32_dpp v18, v18, v18 quad_perm:[1,0,3,2] row_mask:0xf bank_mask:0xf
    s_nop 1
    v_add_f32_dpp v18, v18, v18 quad_perm:[2,3,0,1] row_mask:0xf bank_mask:0xf
    s_nop 1
    v_add_f32_dpp v18, v18, v18 row_half_mirror row_mask:0xf bank_mask:0xf
    s_nop 1
    v_add_f32_dpp v18, v18, v18 row_mirror row_mask:0xf bank_mask:0xf
    v_mov_b32 v19, v18
    s_nop 1
    v_permlane16_swap_b32 v18, v19
    v_add_f32 v18, v18, v19
    s_waitcnt lgkmcnt(0)
    ds_read_b128 v[184:187], v141
    v_rcp_f32 v18, v18
L_W_pchk:
    s_waitcnt vmcnt(0) lgkmcnt(0)
    ds_read_b64_tr_b16 v[52:53], v152 offset:0
    ds_read_b64_tr_b16 v[54:55], v152 offset:1024
    ds_read_b64_tr_b16 v[56:57], v153 offset:0
    ds_read_b64_tr_b16 v[58:59], v153 offset:1024
    ds_read_b64_tr_b16 v[60:61], v154 offset:0
    ds_read_b64_tr_b16 v[62:63], v154 offset:1024
    ds_read_b64_tr_b16 v[64:65], v155 offset:0
    ds_read_b64_tr_b16 v[66:67], v155 offset:1024
    ds_read_b64_tr_b16 v[68:69], v156 offset:0
    ds_read_b64_tr_b16 v[70:71], v156 offset:1024
    ds_read_b64_tr_b16 v[72:73], v157 offset:0
    ds_read_b64_tr_b16 v[74:75], v157 offset:1024
    ds_read_b64_tr_b16 v[76:77], v158 offset:0
    ds_read_b64_tr_b16 v[78:79], v158 offset:1024
    ds_read_b64_tr_b16 v[80:81], v159 offset:0
    ds_read_b64_tr_b16 v[82:83], v159 offset:1024
    s_waitcnt lgkmcnt(14)
    v_mfma_f32_16x16x32_bf16 v[192:195], v[184:187], v[52:55], 0
    v_pk_max_u16 v132, v52, v53
    v_pk_max_u16 v133, v54, v55
    s_waitcnt lgkmcnt(12)
    v_mfma_f32_16x16x32_bf16 v[196:199], v[184:187], v[56:59], 0
    v_pk_max_u16 v132, v132, v56
    v_pk_max_u16 v132, v132, v57
    v_pk_max_u16 v133, v133, v58
    v_pk_max_u16 v133, v133, v59
    s_waitcnt lgkmcnt(10)
    v_mfma_f32_16x16x32_bf16 v[200:203], v[184:187], v[60:63], 0
    v_pk_max_u16 v132, v132, v60
    v_pk_max_u16 v132, v132, v61
    v_pk_max_u16 v133, v133, v62
    v_pk_max_u16 v133, v133, v63
    s_waitcnt lgkmcnt(8)
    v_mfma_f32_16x16x32_bf16 v[204:207], v[184:187], v[64:67], 0
    v_pk_max_u16 v132, v132, v64
    v_pk_max_u16 v132, v132, v65
    v_pk_max_u16 v133, v133, v66
    v_pk_max_u16 v133, v133, v67
    s_waitcnt lgkmcnt(6)
    v_mfma_f32_16x16x32_bf16 v[208:211], v[184:187], v[68:71], 0
    v_pk_max_u16 v132, v132, v68
    v_pk_max_u16 v132, v132, v69
    v_pk_max_u16 v133, v133, v70
    v_pk_max_u16 v133, v133, v71
    s_waitcnt lgkmcnt(4)
    v_mfma_f32_16x16x32_bf16 v[212:215], v[184:187], v[72:75], 0
    v_pk_max_u16 v132, v132, v72
    v_pk_max_u16 v132, v132, v73
    v_pk_max_u16 v133, v133, v74
    v_pk_max_u16 v133, v133, v75
    s_waitcnt lgkmcnt(2)
    v_mfma_f32_16x16x32_bf16 v[216:219], v[184:187], v[76:79], 0
    v_pk_max_u16 v132, v132, v76
    v_pk_max_u16 v132, v132, v77
    v_pk_max_u16 v133, v133, v78
    v_pk_max_u16 v133, v133, v79
    s_waitcnt lgkmcnt(0)
    v_mfma_f32_16x16x32_bf16 v[220:223], v[184:187], v[80:83], 0
    v_pk_max_u16 v132, v132, v80
    v_pk_max_u16 v132, v132, v81
    v_pk_max_u16 v133, v133, v82
    v_pk_max_u16 v133, v133, v83
    v_lshlrev_b32 v134, 16, v132
    v_lshlrev_b32 v135, 16, v133
    v_max_u32 v132, v132, v134
    v_max_u32 v133, v133, v135
    s_mov_b32 s51, 0xffff0000
    v_cmp_le_u32 s[66:67], s51, v132
    v_cmp_le_u32 s[68:69], s51, v133
    s_nop 3
    s_or_b64 vcc, s[66:67], s[68:69]
    s_cbranch_scc0 L_W_partok
    s_sleep 4
    s_add_u32 s55, s55, 1
    s_cmp_gt_u32 s55, 0x40000
    s_cbranch_scc1 L_fail
    s_lshl_b32 s70, s33, 15
    s_bfe_u32 s51, s66, 0x100000
    s_cbranch_scc0 L_W_pr_0
    s_add_u32 m0, s70, 0
    s_movk_i32 s50, 0
    buffer_load_dwordx4 v150, s[44:47], s50 offen sc1 lds
L_W_pr_0:
    s_bfe_u32 s51, s68, 0x100000
    s_cbranch_scc0 L_W_pr_1
    s_add_u32 m0, s70, 1024
    s_movk_i32 s50, 4096
    buffer_load_dwordx4 v150, s[44:47], s50 offen sc1 lds
L_W_pr_1:
    s_bfe_u32 s51, s66, 0x100010
    s_cbranch_scc0 L_W_pr_2
    s_add_u32 m0, s70, 2048
    s_movk_i32 s50, 8192
    buffer_load_dwordx4 v151, s[44:47], s50 offen sc1 lds
L_W_pr_2:
    s_bfe_u32 s51, s68, 0x100010
    s_cbranch_scc0 L_W_pr_3
    s_add_u32 m0, s70, 3072
    s_movk_i32 s50, 12288
    buffer_load_dwordx4 v151, s[44:47], s50 offen sc1 lds
L_W_pr_3:
    s_bfe_u32 s51, s67, 0x100000
    s_cbranch_scc0 L_W_pr_4
    s_add_u32 m0, s70, 4096
    s_movk_i32 s50, 16384
    buffer_load_dwordx4 v150, s[44:47], s50 offen sc1 lds
L_W_pr_4:
    s_bfe_u32 s51, s69, 0x100000
    s_cbranch_scc0 L_W_pr_5
    s_add_u32 m0, s70, 5120
    s_movk_i32 s50, 20480
    buffer_load_dwordx4 v150, s[44:47], s50 offen sc1 lds
L_W_pr_5:
    s_bfe_u32 s51, s67, 0x100010
    s_cbranch_scc0 L_W_pr_6
    s_add_u32 m0, s70, 6144
    s_movk_i32 s50, 24576
    buffer_load_dwordx4 v151, s[44:47], s50 offen sc1 lds
L_W_pr_6:
    s_bfe_u32 s51, s69, 0x100010
    s_cbranch_scc0 L_W_pr_7
    s_add_u32 m0, s70, 7168
    s_movk_i32 s50, 28672
    buffer_load_dwordx4 v151, s[44:47], s50 offen sc1 lds
L_W_pr_7:
    s_branch L_W_pchk
L_W_partok:
    s_nop 0
    v_mov_b32_dpp v192, v196 quad_perm:[0,1,2,3] row_mask:0x2 bank_mask:0xf
    v_mov_b32_dpp v208, v212 quad_perm:[0,1,2,3] row_mask:0x2 bank_mask:0xf
    v_mov_b32_dpp v192, v200 quad_perm:[0,1,2,3] row_mask:0x4 bank_mask:0xf
    v_mov_b32_dpp v208, v216 quad_perm:[0,1,2,3] row_mask:0x4 bank_mask:0xf
    v_mov_b32_dpp v192, v204 quad_perm:[0,1,2,3] row_mask:0x8 bank_mask:0xf
    v_mov_b32_dpp v208, v220 quad_perm:[0,1,2,3] row_mask:0x8 bank_mask:0xf
    v_mul_f32 v192, v192, v18
    v_cvt_pk_bf16_f32 v192, v192, v192
    ds_write_b16 v148, v192 offset:0
    ds_write_b16 v148, v192 offset:512
    v_mul_f32 v208, v208, v18
    v_cvt_pk_bf16_f32 v208, v208, v208
    ds_write_b16 v148, v208 offset:64
    ds_write_b16 v148, v208 offset:576
    s_waitcnt lgkmcnt(0)
    s_barrier
    ds_read_b128 v[52:55], v147 offset:0
    ds_read_b128 v[56:59], v147 offset:64
    ds_read_b128 v[60:63], v147 offset:128
    ds_read_b128 v[64:67], v147 offset:192
    ds_read_b128 v[68:71], v147 offset:256
    ds_read_b128 v[72:75], v147 offset:320
    ds_read_b128 v[76:79], v147 offset:384
    ds_read_b128 v[80:83], v147 offset:448
    s_waitcnt lgkmcnt(7)
    v_smfmac_f32_16x16x64_bf16 v[224:227], v[52:55], a[0:7], v140
    v_smfmac_f32_16x16x64_bf16 v[228:231], v[52:55], a[64:71], v140
    s_waitcnt lgkmcnt(6)
    v_smfmac_f32_16x16x64_bf16 v[224:227], v[56:59], a[8:15], v140
    v_smfmac_f32_16x16x64_bf16 v[228:231], v[56:59], a[72:79], v140
    s_waitcnt lgkmcnt(5)
    v_smfmac_f32_16x16x64_bf16 v[224:227], v[60:63], a[16:23], v140
    v_smfmac_f32_16x16x64_bf16 v[228:231], v[60:63], a[80:87], v140
    s_waitcnt lgkmcnt(4)
    v_smfmac_f32_16x16x64_bf16 v[224:227], v[64:67], a[24:31], v140
    v_smfmac_f32_16x16x64_bf16 v[228:231], v[64:67], a[88:95], v140
    s_waitcnt lgkmcnt(3)
    v_smfmac_f32_16x16x64_bf16 v[224:227], v[68:71], a[32:39], v140
    v_smfmac_f32_16x16x64_bf16 v[228:231], v[68:71], a[96:103], v140
    s_waitcnt lgkmcnt(2)
    v_smfmac_f32_16x16x64_bf16 v[224:227], v[72:75], a[40:47], v140
    v_smfmac_f32_16x16x64_bf16 v[228:231], v[72:75], a[104:111], v140
    s_waitcnt lgkmcnt(1)
    v_smfmac_f32_16x16x64_bf16 v[224:227], v[76:79], a[48:55], v140
    v_smfmac_f32_16x16x64_bf16 v[228:231], v[76:79], a[112:119], v140
    s_waitcnt lgkmcnt(0)
    v_smfmac_f32_16x16x64_bf16 v[224:227], v[80:83], a[56:63], v140
    v_smfmac_f32_16x16x64_bf16 v[228:231], v[80:83], a[120:127], v140
    s_nop 6
    v_add_f32 v224, v224, v225
    v_add_f32 v228, v228, v229
    s_nop 1
    v_mov_b32_dpp v224, v228 quad_perm:[0,1,2,3] row_mask:0xa bank_mask:0xf
    v_cvt_pk_bf16_f32 v224, v224, v224
    ds_write_b16 v145, v224
    ds_write_b16 v145, v224 offset:128
    s_waitcnt lgkmcnt(0)
    s_barrier
    ds_read_b128 v[52:55], v146 offset:0
    ds_read_b128 v[56:59], v146 offset:64
    s_waitcnt lgkmcnt(1)
    v_smfmac_f32_16x16x64_bf16 v[20:23], v[52:55], a[128:135], v140
    v_smfmac_f32_16x16x64_bf16 v[24:27], v[52:55], a[144:151], v140
    v_smfmac_f32_16x16x64_bf16 v[28:31], v[52:55], a[160:167], v140
    v_smfmac_f32_16x16x64_bf16 v[32:35], v[52:55], a[176:183], v140
    v_smfmac_f32_16x16x64_bf16 v[36:39], v[52:55], a[192:199], v140
    v_smfmac_f32_16x16x64_bf16 v[40:43], v[52:55], a[208:215], v140
    v_smfmac_f32_16x16x64_bf16 v[44:47], v[52:55], a[224:231], v140
    v_smfmac_f32_16x16x64_bf16 v[48:51], v[52:55], a[240:247], v140
    s_waitcnt lgkmcnt(0)
    v_smfmac_f32_16x16x64_bf16 v[20:23], v[56:59], a[136:143], v140
    v_smfmac_f32_16x16x64_bf16 v[24:27], v[56:59], a[152:159], v140
    v_smfmac_f32_16x16x64_bf16 v[28:31], v[56:59], a[168:175], v140
    v_smfmac_f32_16x16x64_bf16 v[32:35], v[56:59], a[184:191], v140
    v_smfmac_f32_16x16x64_bf16 v[36:39], v[56:59], a[200:207], v140
    v_smfmac_f32_16x16x64_bf16 v[40:43], v[56:59], a[216:223], v140
    v_smfmac_f32_16x16x64_bf16 v[44:47], v[56:59], a[232:239], v140
    v_smfmac_f32_16x16x64_bf16 v[48:51], v[56:59], a[248:255], v140
    s_nop 0
    v_add_f32 v20, v20, v21
    v_add_f32 v24, v24, v25
    v_add_f32 v28, v28, v29
    v_add_f32 v32, v32, v33
    v_add_f32 v36, v36, v37
    v_add_f32 v40, v40, v41
    v_add_f32 v44, v44, v45
    s_nop 1
    v_add_f32 v48, v48, v49
    s_nop 0
    v_mov_b32_dpp v20, v24 quad_perm:[0,1,2,3] row_mask:0x2 bank_mask:0xf
    v_mov_b32_dpp v36, v40 quad_perm:[0,1,2,3] row_mask:0x2 bank_mask:0xf
    v_mov_b32_dpp v20, v28 quad_perm:[0,1,2,3] row_mask:0x4 bank_mask:0xf
    v_mov_b32_dpp v36, v44 quad_perm:[0,1,2,3] row_mask:0x4 bank_mask:0xf
    v_mov_b32_dpp v20, v32 quad_perm:[0,1,2,3] row_mask:0x8 bank_mask:0xf
    v_mov_b32_dpp v36, v48 quad_perm:[0,1,2,3] row_mask:0x8 bank_mask:0xf
    s_nop 0
    v_mov_b32_dpp v18, v20 quad_perm:[1,0,3,2] row_mask:0xf bank_mask:0xf
    v_mov_b32_dpp v19, v36 quad_perm:[1,0,3,2] row_mask:0xf bank_mask:0xf
    v_cndmask_b32 v19, v20, v19, s[56:57]
    v_cndmask_b32 v18, v18, v36, s[56:57]
    v_cvt_pk_bf16_f32 v18, v19, v18
    s_mov_b32 s51, 0xfffefffe
    v_pk_min_u16 v18, v18, s51
    global_store_dword v149, v18, s[28:29] sc1
    s_endpgm
L_A:
    s_sub_u32 s51, s31, 16
    s_and_b32 s48, s51, 3
    s_lshr_b32 s51, s51, 2
    s_lshl_b32 s51, s51, 3
    s_add_u32 s49, s51, s30
    v_lshlrev_b32 v4, 4, v0
    v_xor_b32 v8, 0, v4
    v_xor_b32 v9, 64, v4
    v_xor_b32 v10, 128, v4
    v_xor_b32 v11, 192, v4
    v_xor_b32 v12, 16, v4
    v_xor_b32 v13, 80, v4
    v_xor_b32 v14, 144, v4
    v_xor_b32 v15, 208, v4
    v_xor_b32 v16, 32, v4
    v_xor_b32 v17, 96, v4
    v_xor_b32 v18, 160, v4
    v_xor_b32 v19, 224, v4
    v_xor_b32 v20, 48, v4
    v_xor_b32 v21, 112, v4
    v_xor_b32 v22, 176, v4
    v_xor_b32 v23, 240, v4
    s_lshl_b32 s51, s48, 22
    s_lshl_b32 s52, s49, 17
    s_add_u32 s51, s51, s52
    s_lshl_b32 s52, s33, 15
    s_add_u32 s51, s51, s52
    s_mov_b32 s61, s51
    v_and_b32 v24, 1, v0
    v_lshlrev_b32 v24, 7, v24
    s_lshl_b32 s51, s48, 5
    s_add_u32 s60, s51, s49
    s_lshl_b32 s52, s60, 10
    s_cmp_eq_u32 s33, 2
    s_cbranch_scc1 L_A_cl2
    s_cmp_eq_u32 s33, 0
    s_mov_b32 s53, 0x30000
    s_cselect_b32 s53, 0, s53
    s_add_u32 s52, s52, s53
    v_add_u32 v59, s52, v4
    s_branch L_A_cld
L_A_cl2:
    s_lshl_b32 s52, s60, 8
    s_add_u32 s52, s52, 0x20000
    s_lshl_b32 s53, s60, 7
    s_add_u32 s53, s53, 0x4ff00
    v_and_b32 v59, 15, v0
    v_lshlrev_b32 v59, 4, v59
    v_add_u32 v59, s52, v59
    v_add_u32 v5, s53, v4
    v_lshrrev_b32 v6, 3, v0
    v_cmp_eq_u32 vcc, 2, v6
    s_nop 1
    v_cndmask_b32 v59, v59, v5, vcc
L_A_cld:
    v_mov_b32 v60, -1
    v_mov_b32 v61, -1
    v_mov_b32 v62, -1
    v_mov_b32 v63, -1
    s_waitcnt lgkmcnt(0)
    global_store_dwordx4 v59, v[60:63], s[28:29] sc1
    s_sub_u32 s51, s31, 16
    s_lshl_b32 s51, s51, 2
    s_add_u32 s51, s51, s33
    s_lshl_b32 s51, s51, 16
    s_lshl_b32 s52, s30, 10
    s_add_u32 s51, s51, s52
    v_lshrrev_b32 v1, 3, v0
    v_lshlrev_b32 v1, 13, v1
    v_and_b32 v2, 7, v0
    v_lshl_add_u32 v1, v2, 7, v1
    v_add_u32 v1, s51, v1
    global_load_dword v250, v1, s[8:9]
    global_load_dword v251, v1, s[10:11]
    v_and_b32 v5, 3, v0
    v_lshlrev_b32 v5, 2, v5
    v_bfe_u32 v6, v0, 2, 2
    v_or_b32 v5, v5, v6
    v_lshrrev_b32 v6, 5, v0
    v_xor_b32 v5, v5, v6
    v_lshlrev_b32 v5, 4, v5
    v_and_b32 v7, 31, v0
    v_lshl_add_u32 v5, v7, 10, v5
    s_lshl_b32 s51, s33, 15
    v_add_u32 v26, s51, v5
    v_xor_b32 v27, 32, v26
    v_xor_b32 v28, 64, v26
    v_xor_b32 v29, 96, v26
    v_xor_b32 v30, 128, v26
    v_xor_b32 v31, 160, v26
    v_xor_b32 v32, 192, v26
    v_xor_b32 v33, 224, v26
    v_bfe_u32 v64, v0, 2, 2
    v_lshlrev_b32 v65, 2, v6
    v_add_u32 v65, v65, v64
    v_lshlrev_b32 v65, 10, v65
    v_bfe_u32 v66, v0, 4, 1
    v_lshlrev_b32 v66, 1, v66
    v_bfe_u32 v67, v0, 1, 1
    v_or_b32 v66, v66, v67
    v_xor_b32 v66, v66, v6
    v_lshl_or_b32 v66, v64, 2, v66
    v_lshl_add_u32 v65, v66, 4, v65
    v_and_b32 v66, 1, v0
    v_lshl_add_u32 v65, v66, 3, v65
    s_lshl_b32 s51, s33, 8
    v_add_u32 v65, s51, v65
    v_xor_b32 v34, 0, v65
    v_add_u32 v35, 0x10000, v34
    v_xor_b32 v36, 32, v65
    v_add_u32 v37, 0x10000, v36
    v_xor_b32 v38, 64, v65
    v_add_u32 v39, 0x10000, v38
    v_xor_b32 v40, 96, v65
    v_add_u32 v41, 0x10000, v40
    v_xor_b32 v42, 128, v65
    v_add_u32 v43, 0x10000, v42
    v_xor_b32 v44, 160, v65
    v_add_u32 v45, 0x10000, v44
    v_xor_b32 v46, 192, v65
    v_add_u32 v47, 0x10000, v46
    v_xor_b32 v48, 224, v65
    v_add_u32 v49, 0x10000, v48
    s_lshl_b32 s51, s33, 1
    s_and_b32 s52, s51, 3
    s_lshl_b32 s52, s52, 4
    s_add_u32 s51, s51, 1
    s_and_b32 s51, s51, 3
    s_lshl_b32 s51, s51, 4
    v_xor_b32 v50, 0, v4
    v_xor_b32 v50, s52, v50
    v_xor_b32 v51, 64, v4
    v_xor_b32 v51, s52, v51
    v_xor_b32 v52, 128, v4
    v_xor_b32 v52, s52, v52
    v_xor_b32 v53, 192, v4
    v_xor_b32 v53, s52, v53
    v_xor_b32 v54, 0, v4
    v_xor_b32 v54, s51, v54
    v_xor_b32 v55, 64, v4
    v_xor_b32 v55, s51, v55
    v_xor_b32 v56, 128, v4
    v_xor_b32 v56, s51, v56
    v_xor_b32 v57, 192, v4
    v_xor_b32 v57, s51, v57
    s_lshl_b32 s51, s33, 13
    s_add_u32 s51, s51, 131072
    v_add_u32 v58, s51, v4
    s_mov_b32 s54, s51
    s_lshl_b32 s52, s48, 15
    s_lshl_b32 s53, s33, 13
    s_add_u32 s52, s52, s53
    s_mov_b32 s40, s28
    s_mov_b32 s41, s29
    s_add_u32 s40, s40, s52
    s_addc_u32 s41, s41, 0
    s_mov_b32 s42, 0x2000
    s_mov_b32 s43, 0x20000
    v_lshlrev_b32 v5, 4, v7
    s_lshl_b32 s51, s33, 2
    s_add_u32 s51, s51, 0
    v_add_u32 v200, s51, v5
    v_add_u32 v201, 0, v5
    s_lshl_b32 s51, s33, 11
    s_add_u32 s51, s51, 1024
    v_add_u32 v202, s51, v4
    v_add_u32 v203, 1024, v4
    s_lshl_b32 s51, s60, 8
    s_add_u32 s51, s51, 0x20000
    v_lshlrev_b32 v5, 3, v7
    v_add_u32 v204, s51, v5
    s_lshl_b32 s51, s33, 12
    s_add_u32 s51, s51, 16384
    v_add_u32 v232, s51, v4
    v_lshlrev_b32 v64, 7, v7
    v_add_u32 v64, s51, v64
    v_and_b32 v65, 7, v7
    v_xor_b32 v65, v65, v6
    v_lshl_add_u32 v224, v65, 4, v64
    v_xor_b32 v225, 32, v224
    v_xor_b32 v226, 64, v224
    v_xor_b32 v227, 96, v224
    v_lshrrev_b32 v64, 3, v0
    v_and_b32 v65, 7, v0
    v_xor_b32 v65, v65, v64
    v_lshlrev_b32 v65, 4, v65
    v_lshl_add_u32 v65, v64, 15, v65
    s_lshl_b32 s51, s48, 20
    s_lshl_b32 s52, s49, 10
    s_add_u32 s51, s51, s52
    s_lshl_b32 s52, s33, 8
    s_add_u32 s51, s51, s52
    s_add_u32 s51, s51, 0x100000
    v_add_u32 v233, s51, v65
    v_add_u32 v234, 0x40000, v233
    v_add_u32 v235, 0x80000, v233
    v_add_u32 v236, 0xc0000, v233
    s_waitcnt vmcnt(2)
    s_barrier
    s_cmp_lg_u32 s33, 0
    s_cbranch_scc1 L_A_noat
    s_and_b32 s51, s60, 1
    s_lshl_b32 s51, s51, 7
    v_mov_b32 v5, s51
    v_mov_b32 v6, 1
    s_mov_b64 exec, 1
    global_atomic_add v5, v6, s[26:27] sc1
    s_mov_b64 exec, -1
L_A_noat:
    s_lshl_b32 m0, s33, 15
    s_mov_b32 s50, 0
    s_mov_b32 s36, s6
    s_mov_b32 s37, s7
    s_add_u32 s36, s36, s61
    s_addc_u32 s37, s37, 0
    s_mov_b32 s38, 0x8000
    s_mov_b32 s39, 0x20000
    buffer_load_dwordx4 v8, s[36:39], s50 offen offset:0 nt lds
    buffer_load_dwordx4 v9, s[36:39], s50 offen offset:1024 nt lds
    buffer_load_dwordx4 v10, s[36:39], s50 offen offset:2048 nt lds
    buffer_load_dwordx4 v11, s[36:39], s50 offen offset:3072 nt lds
    s_add_u32 m0, m0, 0x1000
    s_add_u32 s50, s50, 0x1000
    buffer_load_dwordx4 v12, s[36:39], s50 offen offset:0 nt lds
    buffer_load_dwordx4 v13, s[36:39], s50 offen offset:1024 nt lds
    buffer_load_dwordx4 v14, s[36:39], s50 offen offset:2048 nt lds
    buffer_load_dwordx4 v15, s[36:39], s50 offen offset:3072 nt lds
    s_add_u32 m0, m0, 0x1000
    s_add_u32 s50, s50, 0x1000
    buffer_load_dwordx4 v16, s[36:39], s50 offen offset:0 nt lds
    buffer_load_dwordx4 v17, s[36:39], s50 offen offset:1024 nt lds
    buffer_load_dwordx4 v18, s[36:39], s50 offen offset:2048 nt lds
    buffer_load_dwordx4 v19, s[36:39], s50 offen offset:3072 nt lds
    s_add_u32 m0, m0, 0x1000
    s_add_u32 s50, s50, 0x1000
    buffer_load_dwordx4 v20, s[36:39], s50 offen offset:0 nt lds
    buffer_load_dwordx4 v21, s[36:39], s50 offen offset:1024 nt lds
    buffer_load_dwordx4 v22, s[36:39], s50 offen offset:2048 nt lds
    buffer_load_dwordx4 v23, s[36:39], s50 offen offset:3072 nt lds
    s_add_u32 m0, m0, 0x1000
    s_add_u32 s50, s50, 0x1000
    buffer_load_dwordx4 v8, s[36:39], s50 offen offset:0 nt lds
    buffer_load_dwordx4 v9, s[36:39], s50 offen offset:1024 nt lds
    buffer_load_dwordx4 v10, s[36:39], s50 offen offset:2048 nt lds
    buffer_load_dwordx4 v11, s[36:39], s50 offen offset:3072 nt lds
    s_add_u32 m0, m0, 0x1000
    s_add_u32 s50, s50, 0x1000
    buffer_load_dwordx4 v12, s[36:39], s50 offen offset:0 nt lds
    buffer_load_dwordx4 v13, s[36:39], s50 offen offset:1024 nt lds
    buffer_load_dwordx4 v14, s[36:39], s50 offen offset:2048 nt lds
    buffer_load_dwordx4 v15, s[36:39], s50 offen offset:3072 nt lds
    s_add_u32 m0, m0, 0x1000
    s_add_u32 s50, s50, 0x1000
    global_load_dword v25, v24, s[26:27] sc1
    buffer_load_dwordx4 v16, s[36:39], s50 offen offset:0 nt lds
    buffer_load_dwordx4 v17, s[36:39], s50 offen offset:1024 nt lds
    buffer_load_dwordx4 v18, s[36:39], s50 offen offset:2048 nt lds
    buffer_load_dwordx4 v19, s[36:39], s50 offen offset:3072 nt lds
    s_add_u32 m0, m0, 0x1000
    s_add_u32 s50, s50, 0x1000
    buffer_load_dwordx4 v20, s[36:39], s50 offen offset:0 nt lds
    buffer_load_dwordx4 v21, s[36:39], s50 offen offset:1024 nt lds
    buffer_load_dwordx4 v22, s[36:39], s50 offen offset:2048 nt lds
    buffer_load_dwordx4 v23, s[36:39], s50 offen offset:3072 nt lds
    s_waitcnt vmcnt(0)
    s_barrier
L_A_cnt:
    v_cmp_gt_u32 vcc, 64, v25
    s_cbranch_vccz L_A_cntok
    s_sleep 16
    s_add_u32 s55, s55, 1
    s_cmp_gt_u32 s55, 0x40000
    s_cbranch_scc1 L_fail
    global_load_dword v25, v24, s[26:27] sc1
    s_waitcnt vmcnt(0)
    s_branch L_A_cnt
L_A_cntok:
    s_mov_b32 m0, s54
    s_mov_b32 s50, 0
    buffer_load_dwordx4 v50, s[40:43], s50 offen offset:0 sc1 lds
    buffer_load_dwordx4 v51, s[40:43], s50 offen offset:1024 sc1 lds
    buffer_load_dwordx4 v52, s[40:43], s50 offen offset:2048 sc1 lds
    buffer_load_dwordx4 v53, s[40:43], s50 offen offset:3072 sc1 lds
    s_add_u32 m0, m0, 0x1000
    s_mov_b32 s50, 0x1000
    buffer_load_dwordx4 v54, s[40:43], s50 offen offset:0 sc1 lds
    buffer_load_dwordx4 v55, s[40:43], s50 offen offset:1024 sc1 lds
    buffer_load_dwordx4 v56, s[40:43], s50 offen offset:2048 sc1 lds
    buffer_load_dwordx4 v57, s[40:43], s50 offen offset:3072 sc1 lds
L_A_frag:
    ds_read_b128 a[0:3], v26 offset:0
    ds_read_b128 a[4:7], v27 offset:0
    ds_read_b128 a[8:11], v28 offset:0
    ds_read_b128 a[12:15], v29 offset:0
    ds_read_b128 a[16:19], v30 offset:0
    ds_read_b128 a[20:23], v31 offset:0
    ds_read_b128 a[24:27], v32 offset:0
    ds_read_b128 a[28:31], v33 offset:0
    ds_read_b128 a[32:35], v26 offset:256
    ds_read_b128 a[36:39], v27 offset:256
    ds_read_b128 a[40:43], v28 offset:256
    ds_read_b128 a[44:47], v29 offset:256
    ds_read_b128 a[48:51], v30 offset:256
    ds_read_b128 a[52:55], v31 offset:256
    ds_read_b128 a[56:59], v32 offset:256
    ds_read_b128 a[60:63], v33 offset:256
    ds_read_b128 a[64:67], v26 offset:512
    ds_read_b128 a[68:71], v27 offset:512
    ds_read_b128 a[72:75], v28 offset:512
    ds_read_b128 a[76:79], v29 offset:512
    ds_read_b128 a[80:83], v30 offset:512
    ds_read_b128 a[84:87], v31 offset:512
    ds_read_b128 a[88:91], v32 offset:512
    ds_read_b128 a[92:95], v33 offset:512
    ds_read_b128 a[96:99], v26 offset:768
    ds_read_b128 a[100:103], v27 offset:768
    ds_read_b128 a[104:107], v28 offset:768
    ds_read_b128 a[108:111], v29 offset:768
    ds_read_b128 a[112:115], v30 offset:768
    ds_read_b128 a[116:119], v31 offset:768
    ds_read_b128 a[120:123], v32 offset:768
    ds_read_b128 a[124:127], v33 offset:768
    ds_read_b64_tr_b16 a[128:129], v34 offset:0
    ds_read_b64_tr_b16 a[130:131], v36 offset:8192
    ds_read_b64_tr_b16 a[132:133], v34 offset:16384
    ds_read_b64_tr_b16 a[134:135], v36 offset:24576
    ds_read_b64_tr_b16 a[136:137], v34 offset:32768
    ds_read_b64_tr_b16 a[138:139], v36 offset:40960
    ds_read_b64_tr_b16 a[140:141], v34 offset:49152
    ds_read_b64_tr_b16 a[142:143], v36 offset:57344
    ds_read_b64_tr_b16 a[144:145], v35 offset:0
    ds_read_b64_tr_b16 a[146:147], v37 offset:8192
    ds_read_b64_tr_b16 a[148:149], v35 offset:16384
    ds_read_b64_tr_b16 a[150:151], v37 offset:24576
    ds_read_b64_tr_b16 a[152:153], v35 offset:32768
    ds_read_b64_tr_b16 a[154:155], v37 offset:40960
    ds_read_b64_tr_b16 a[156:157], v35 offset:49152
    ds_read_b64_tr_b16 a[158:159], v37 offset:57344
    ds_read_b64_tr_b16 a[160:161], v38 offset:0
    ds_read_b64_tr_b16 a[162:163], v40 offset:8192
    ds_read_b64_tr_b16 a[164:165], v38 offset:16384
    ds_read_b64_tr_b16 a[166:167], v40 offset:24576
    ds_read_b64_tr_b16 a[168:169], v38 offset:32768
    ds_read_b64_tr_b16 a[170:171], v40 offset:40960
    ds_read_b64_tr_b16 a[172:173], v38 offset:49152
    ds_read_b64_tr_b16 a[174:175], v40 offset:57344
    ds_read_b64_tr_b16 a[176:177], v39 offset:0
    ds_read_b64_tr_b16 a[178:179], v41 offset:8192
    ds_read_b64_tr_b16 a[180:181], v39 offset:16384
    ds_read_b64_tr_b16 a[182:183], v41 offset:24576
    ds_read_b64_tr_b16 a[184:185], v39 offset:32768
    ds_read_b64_tr_b16 a[186:187], v41 offset:40960
    ds_read_b64_tr_b16 a[188:189], v39 offset:49152
    ds_read_b64_tr_b16 a[190:191], v41 offset:57344
    ds_read_b64_tr_b16 a[192:193], v42 offset:0
    ds_read_b64_tr_b16 a[194:195], v44 offset:8192
    ds_read_b64_tr_b16 a[196:197], v42 offset:16384
    ds_read_b64_tr_b16 a[198:199], v44 offset:24576
    ds_read_b64_tr_b16 a[200:201], v42 offset:32768
    ds_read_b64_tr_b16 a[202:203], v44 offset:40960
    ds_read_b64_tr_b16 a[204:205], v42 offset:49152
    ds_read_b64_tr_b16 a[206:207], v44 offset:57344
    ds_read_b64_tr_b16 a[208:209], v43 offset:0
    ds_read_b64_tr_b16 a[210:211], v45 offset:8192
    ds_read_b64_tr_b16 a[212:213], v43 offset:16384
    ds_read_b64_tr_b16 a[214:215], v45 offset:24576
    ds_read_b64_tr_b16 a[216:217], v43 offset:32768
    ds_read_b64_tr_b16 a[218:219], v45 offset:40960
    ds_read_b64_tr_b16 a[220:221], v43 offset:49152
    ds_read_b64_tr_b16 a[222:223], v45 offset:57344
    ds_read_b64_tr_b16 a[224:225], v46 offset:0
    ds_read_b64_tr_b16 a[226:227], v48 offset:8192
    ds_read_b64_tr_b16 a[228:229], v46 offset:16384
    ds_read_b64_tr_b16 a[230:231], v48 offset:24576
    ds_read_b64_tr_b16 a[232:233], v46 offset:32768
    ds_read_b64_tr_b16 a[234:235], v48 offset:40960
    ds_read_b64_tr_b16 a[236:237], v46 offset:49152
    ds_read_b64_tr_b16 a[238:239], v48 offset:57344
    ds_read_b64_tr_b16 a[240:241], v47 offset:0
    ds_read_b64_tr_b16 a[242:243], v49 offset:8192
    ds_read_b64_tr_b16 a[244:245], v47 offset:16384
    ds_read_b64_tr_b16 a[246:247], v49 offset:24576
    ds_read_b64_tr_b16 a[248:249], v47 offset:32768
    ds_read_b64_tr_b16 a[250:251], v49 offset:40960
    ds_read_b64_tr_b16 a[252:253], v47 offset:49152
    ds_read_b64_tr_b16 a[254:255], v49 offset:57344
    s_lshl_b32 s51, s33, 15
    s_sub_u32 s51, 131072, s51
    v_add_u32 v26, s51, v26
    v_add_u32 v27, s51, v27
    v_add_u32 v28, s51, v28
    v_add_u32 v29, s51, v29
    v_add_u32 v30, s51, v30
    v_add_u32 v31, s51, v31
    v_add_u32 v32, s51, v32
    v_add_u32 v33, s51, v33
    s_mov_b32 s64, 1
    s_branch L_A_qachk
L_A_qa:
    s_mov_b32 m0, s54
    s_mov_b32 s50, 0
    buffer_load_dwordx4 v50, s[40:43], s50 offen offset:0 sc1 lds
    buffer_load_dwordx4 v51, s[40:43], s50 offen offset:1024 sc1 lds
    buffer_load_dwordx4 v52, s[40:43], s50 offen offset:2048 sc1 lds
    buffer_load_dwordx4 v53, s[40:43], s50 offen offset:3072 sc1 lds
    s_add_u32 m0, m0, 0x1000
    s_mov_b32 s50, 0x1000
    buffer_load_dwordx4 v54, s[40:43], s50 offen offset:0 sc1 lds
    buffer_load_dwordx4 v55, s[40:43], s50 offen offset:1024 sc1 lds
    buffer_load_dwordx4 v56, s[40:43], s50 offen offset:2048 sc1 lds
    buffer_load_dwordx4 v57, s[40:43], s50 offen offset:3072 sc1 lds
L_A_qachk:
    s_waitcnt vmcnt(0)
    ds_read_b128 v[60:63], v58 offset:0
    ds_read_b128 v[64:67], v58 offset:1024
    ds_read_b128 v[68:71], v58 offset:2048
    ds_read_b128 v[72:75], v58 offset:3072
    ds_read_b128 v[76:79], v58 offset:4096
    ds_read_b128 v[80:83], v58 offset:5120
    ds_read_b128 v[84:87], v58 offset:6144
    ds_read_b128 v[88:91], v58 offset:7168
    s_waitcnt lgkmcnt(0)
    v_max3_u32 v60, v60, v61, v62
    v_max3_u32 v60, v60, v63, v64
    v_max3_u32 v60, v60, v65, v66
    v_max3_u32 v60, v60, v67, v68
    v_max3_u32 v60, v60, v69, v70
    v_max3_u32 v60, v60, v71, v72
    v_max3_u32 v60, v60, v73, v74
    v_max3_u32 v60, v60, v75, v76
    v_max3_u32 v60, v60, v77, v78
    v_max3_u32 v60, v60, v79, v80
    v_max3_u32 v60, v60, v81, v82
    v_max3_u32 v60, v60, v83, v84
    v_max3_u32 v60, v60, v85, v86
    v_max3_u32 v60, v60, v87, v88
    v_max3_u32 v60, v60, v89, v90
    v_max_u32 v60, v60, v91
    v_cmp_eq_u32 vcc, -1, v60
    s_cbranch_vccz L_A_qaok
    s_sleep 2
    s_add_u32 s55, s55, 1
    s_cmp_gt_u32 s55, 0x40000
    s_cbranch_scc1 L_fail
    s_branch L_A_qa
L_A_qaok:
    s_barrier
    v_mov_b32 v92, -1
    v_mov_b32 v93, -1
    v_mov_b32 v94, -1
    v_mov_b32 v95, -1
    ds_read_b128 v[112:115], v26 offset:0
    ds_read_b128 v[116:119], v27 offset:0
    ds_read_b128 v[120:123], v28 offset:0
    ds_read_b128 v[124:127], v29 offset:0
    ds_read_b128 v[128:131], v30 offset:0
    ds_read_b128 v[132:135], v31 offset:0
    s_waitcnt lgkmcnt(5)
    v_mfma_f32_32x32x16_bf16 v[96:111], a[0:3], v[112:115], 0
    ds_read_b128 v[112:115], v32 offset:0
    global_store_dwordx4 v233, v[92:95], s[28:29] offset:0 sc1
    s_waitcnt lgkmcnt(5)
    v_mfma_f32_32x32x16_bf16 v[96:111], a[4:7], v[116:119], v[96:111]
    ds_read_b128 v[116:119], v33 offset:0
    s_waitcnt lgkmcnt(5)
    v_mfma_f32_32x32x16_bf16 v[96:111], a[8:11], v[120:123], v[96:111]
    ds_read_b128 v[120:123], v26 offset:256
    s_waitcnt lgkmcnt(5)
    v_mfma_f32_32x32x16_bf16 v[96:111], a[12:15], v[124:127], v[96:111]
    ds_read_b128 v[124:127], v27 offset:256
    global_store_dwordx4 v234, v[92:95], s[28:29] offset:0 sc1
    s_waitcnt lgkmcnt(5)
    v_mfma_f32_32x32x16_bf16 v[96:111], a[16:19], v[128:131], v[96:111]
    ds_read_b128 v[128:131], v28 offset:256
    s_waitcnt lgkmcnt(5)
    v_mfma_f32_32x32x16_bf16 v[96:111], a[20:23], v[132:135], v[96:111]
    ds_read_b128 v[132:135], v29 offset:256
    s_waitcnt lgkmcnt(5)
    v_mfma_f32_32x32x16_bf16 v[96:111], a[24:27], v[112:115], v[96:111]
    ds_read_b128 v[112:115], v30 offset:256
    global_store_dwordx4 v235, v[92:95], s[28:29] offset:0 sc1
    s_waitcnt lgkmcnt(5)
    v_mfma_f32_32x32x16_bf16 v[96:111], a[28:31], v[116:119], v[96:111]
    ds_read_b128 v[116:119], v31 offset:256
    s_waitcnt lgkmcnt(5)
    v_mfma_f32_32x32x16_bf16 v[96:111], a[32:35], v[120:123], v[96:111]
    ds_read_b128 v[120:123], v32 offset:256
    s_waitcnt lgkmcnt(5)
    v_mfma_f32_32x32x16_bf16 v[96:111], a[36:39], v[124:127], v[96:111]
    ds_read_b128 v[124:127], v33 offset:256
    global_store_dwordx4 v236, v[92:95], s[28:29] offset:0 sc1
    s_waitcnt lgkmcnt(5)
    v_mfma_f32_32x32x16_bf16 v[96:111], a[40:43], v[128:131], v[96:111]
    ds_read_b128 v[128:131], v26 offset:512
    s_waitcnt lgkmcnt(5)
    v_mfma_f32_32x32x16_bf16 v[96:111], a[44:47], v[132:135], v[96:111]
    ds_read_b128 v[132:135], v27 offset:512
    s_waitcnt lgkmcnt(5)
    v_mfma_f32_32x32x16_bf16 v[96:111], a[48:51], v[112:115], v[96:111]
    ds_read_b128 v[112:115], v28 offset:512
    global_store_dwordx4 v233, v[92:95], s[28:29] offset:128 sc1
    s_waitcnt lgkmcnt(5)
    v_mfma_f32_32x32x16_bf16 v[96:111], a[52:55], v[116:119], v[96:111]
    ds_read_b128 v[116:119], v29 offset:512
    s_waitcnt lgkmcnt(5)
    v_mfma_f32_32x32x16_bf16 v[96:111], a[56:59], v[120:123], v[96:111]
    ds_read_b128 v[120:123], v30 offset:512
    s_waitcnt lgkmcnt(5)
    v_mfma_f32_32x32x16_bf16 v[96:111], a[60:63], v[124:127], v[96:111]
    ds_read_b128 v[124:127], v31 offset:512
    global_store_dwordx4 v234, v[92:95], s[28:29] offset:128 sc1
    s_waitcnt lgkmcnt(5)
    v_mfma_f32_32x32x16_bf16 v[96:111], a[64:67], v[128:131], v[96:111]
    ds_read_b128 v[128:131], v32 offset:512
    s_waitcnt lgkmcnt(5)
    v_mfma_f32_32x32x16_bf16 v[96:111], a[68:71], v[132:135], v[96:111]
    ds_read_b128 v[132:135], v33 offset:512
    s_waitcnt lgkmcnt(5)
    v_mfma_f32_32x32x16_bf16 v[96:111], a[72:75], v[112:115], v[96:111]
    ds_read_b128 v[112:115], v26 offset:768
    global_store_dwordx4 v235, v[92:95], s[28:29] offset:128 sc1
    s_waitcnt lgkmcnt(5)
    v_mfma_f32_32x32x16_bf16 v[96:111], a[76:79], v[116:119], v[96:111]
    ds_read_b128 v[116:119], v27 offset:768
    s_waitcnt lgkmcnt(5)
    v_mfma_f32_32x32x16_bf16 v[96:111], a[80:83], v[120:123], v[96:111]
    ds_read_b128 v[120:123], v28 offset:768
    s_waitcnt lgkmcnt(5)
    v_mfma_f32_32x32x16_bf16 v[96:111], a[84:87], v[124:127], v[96:111]
    ds_read_b128 v[124:127], v29 offset:768
    global_store_dwordx4 v236, v[92:95], s[28:29] offset:128 sc1
    s_waitcnt lgkmcnt(5)
    v_mfma_f32_32x32x16_bf16 v[96:111], a[88:91], v[128:131], v[96:111]
    ds_read_b128 v[128:131], v30 offset:768
    s_waitcnt lgkmcnt(5)
    v_mfma_f32_32x32x16_bf16 v[96:111], a[92:95], v[132:135], v[96:111]
    ds_read_b128 v[132:135], v31 offset:768
    s_waitcnt lgkmcnt(5)
    v_mfma_f32_32x32x16_bf16 v[96:111], a[96:99], v[112:115], v[96:111]
    ds_read_b128 v[112:115], v32 offset:768
    s_waitcnt lgkmcnt(5)
    v_mfma_f32_32x32x16_bf16 v[96:111], a[100:103], v[116:119], v[96:111]
    ds_read_b128 v[116:119], v33 offset:768
    s_waitcnt lgkmcnt(5)
    v_mfma_f32_32x32x16_bf16 v[96:111], a[104:107], v[120:123], v[96:111]
    s_waitcnt lgkmcnt(4)
    v_mfma_f32_32x32x16_bf16 v[96:111], a[108:111], v[124:127], v[96:111]
    s_waitcnt lgkmcnt(3)
    v_mfma_f32_32x32x16_bf16 v[96:111], a[112:115], v[128:131], v[96:111]
    s_waitcnt lgkmcnt(2)
    v_mfma_f32_32x32x16_bf16 v[96:111], a[116:119], v[132:135], v[96:111]
    s_waitcnt lgkmcnt(1)
    v_mfma_f32_32x32x16_bf16 v[96:111], a[120:123], v[112:115], v[96:111]
    s_waitcnt lgkmcnt(0)
    v_mfma_f32_32x32x16_bf16 v[96:111], a[124:127], v[116:119], v[96:111]
    s_nop 11
    v_max3_f32 v60, v96, v97, v98
    v_max3_f32 v61, v99, v100, v101
    v_max3_f32 v60, v60, v102, v103
    v_max3_f32 v61, v61, v104, v105
    v_max3_f32 v60, v60, v106, v107
    v_max3_f32 v61, v61, v108, v109
    v_max3_f32 v60, v60, v110, v111
    v_max_f32 v60, v60, v61
    v_mov_b32 v61, v60
    s_nop 1
    v_permlane32_swap_b32 v60, v61
    v_max_f32 v60, v60, v61
    ds_write_b32 v200, v60
    v_sub_f32 v96, v96, v60
    v_sub_f32 v97, v97, v60
    v_sub_f32 v98, v98, v60
    v_sub_f32 v99, v99, v60
    v_sub_f32 v100, v100, v60
    v_sub_f32 v101, v101, v60
    v_sub_f32 v102, v102, v60
    v_sub_f32 v103, v103, v60
    v_sub_f32 v104, v104, v60
    v_sub_f32 v105, v105, v60
    v_sub_f32 v106, v106, v60
    v_sub_f32 v107, v107, v60
    v_sub_f32 v108, v108, v60
    v_sub_f32 v109, v109, v60
    v_sub_f32 v110, v110, v60
    v_sub_f32 v111, v111, v60
    s_waitcnt lgkmcnt(0)
    s_barrier
    ds_read_b128 v[64:67], v201
    v_exp_f32 v96, v96
    v_exp_f32 v97, v97
    v_exp_f32 v98, v98
    v_exp_f32 v99, v99
    v_exp_f32 v100, v100
    v_exp_f32 v101, v101
    v_exp_f32 v102, v102
    v_exp_f32 v103, v103
    v_exp_f32 v104, v104
    v_exp_f32 v105, v105
    v_exp_f32 v106, v106
    v_exp_f32 v107, v107
    v_exp_f32 v108, v108
    v_exp_f32 v109, v109
    v_exp_f32 v110, v110
    v_exp_f32 v111, v111
    s_waitcnt lgkmcnt(0)
    v_max3_f32 v62, v64, v65, v66
    v_max_f32 v62, v62, v67
    v_sub_f32 v63, v60, v62
    v_exp_f32 v63, v63
    s_nop 0
    v_pk_mul_f32 v[96:97], v[96:97], v[62:63] op_sel:[0,1] op_sel_hi:[1,1]
    v_pk_mul_f32 v[98:99], v[98:99], v[62:63] op_sel:[0,1] op_sel_hi:[1,1]
    v_pk_mul_f32 v[100:101], v[100:101], v[62:63] op_sel:[0,1] op_sel_hi:[1,1]
    v_pk_mul_f32 v[102:103], v[102:103], v[62:63] op_sel:[0,1] op_sel_hi:[1,1]
    v_pk_mul_f32 v[104:105], v[104:105], v[62:63] op_sel:[0,1] op_sel_hi:[1,1]
    v_pk_mul_f32 v[106:107], v[106:107], v[62:63] op_sel:[0,1] op_sel_hi:[1,1]
    v_pk_mul_f32 v[108:109], v[108:109], v[62:63] op_sel:[0,1] op_sel_hi:[1,1]
    v_pk_mul_f32 v[110:111], v[110:111], v[62:63] op_sel:[0,1] op_sel_hi:[1,1]
    v_cvt_pk_bf16_f32 v68, v96, v97
    v_cvt_pk_bf16_f32 v69, v98, v99
    v_cvt_pk_bf16_f32 v70, v100, v101
    v_cvt_pk_bf16_f32 v71, v102, v103
    v_cvt_pk_bf16_f32 v72, v104, v105
    v_cvt_pk_bf16_f32 v73, v106, v107
    v_cvt_pk_bf16_f32 v74, v108, v109
    v_cvt_pk_bf16_f32 v75, v110, v111
    ds_write_b128 v202, v[68:71]
    ds_write_b128 v202, v[72:75] offset:1024
    s_waitcnt lgkmcnt(0)
    s_barrier
    ds_read_b128 v[136:139], v203 offset:0
    ds_read_b128 v[140:143], v203 offset:1024
    ds_read_b128 v[144:147], v203 offset:2048
    ds_read_b128 v[148:151], v203 offset:3072
    ds_read_b128 v[152:155], v203 offset:4096
    ds_read_b128 v[156:159], v203 offset:5120
    ds_read_b128 v[160:163], v203 offset:6144
    ds_read_b128 v[164:167], v203 offset:7168
    s_mov_b32 s65, 0xfffefffe
    s_waitcnt lgkmcnt(7)
    v_mfma_f32_32x32x16_bf16 v[168:183], a[128:131], v[136:139], 0
    s_waitcnt lgkmcnt(6)
    v_mfma_f32_32x32x16_bf16 v[168:183], a[132:135], v[140:143], v[168:183]
    v_pk_add_f32 v[96:97], v[96:97], v[104:105]
    v_pk_add_f32 v[98:99], v[98:99], v[106:107]
    v_pk_add_f32 v[100:101], v[100:101], v[108:109]
    s_waitcnt lgkmcnt(0)
    v_mfma_f32_32x32x16_bf16 v[168:183], a[136:139], v[144:147], v[168:183]
    v_pk_add_f32 v[102:103], v[102:103], v[110:111]
    v_pk_add_f32 v[96:97], v[96:97], v[100:101]
    v_pk_add_f32 v[98:99], v[98:99], v[102:103]
    v_mfma_f32_32x32x16_bf16 v[168:183], a[140:143], v[148:151], v[168:183]
    v_pk_add_f32 v[96:97], v[96:97], v[98:99]
    v_add_f32 v64, v96, v97
    v_mov_b32 v65, v64
    v_mfma_f32_32x32x16_bf16 v[168:183], a[144:147], v[152:155], v[168:183]
    s_nop 1
    v_permlane32_swap_b32 v64, v65
    v_add_f32 v64, v64, v65
    v_mfma_f32_32x32x16_bf16 v[168:183], a[148:151], v[156:159], v[168:183]
    ds_write_b32 v200, v64 offset:512
    v_min_u32 v62, -2, v62
    v_mfma_f32_32x32x16_bf16 v[168:183], a[152:155], v[160:163], v[168:183]
    v_mfma_f32_32x32x16_bf16 v[168:183], a[156:159], v[164:167], v[168:183]
    s_waitcnt vmcnt(0) lgkmcnt(0)
    s_barrier
    ds_read_b128 v[64:67], v201 offset:512
    v_mfma_f32_32x32x16_bf16 v[184:199], a[160:163], v[136:139], 0
    v_mfma_f32_32x32x16_bf16 v[184:199], a[164:167], v[140:143], v[184:199]
    s_waitcnt lgkmcnt(0)
    v_add_f32 v64, v64, v65
    v_add_f32 v66, v66, v67
    v_add_f32 v63, v64, v66
    v_min_u32 v63, -2, v63
    s_cmp_lg_u32 s33, 0
    s_cbranch_scc1 L_A_noml
    s_mov_b32 exec_hi, 0
    global_store_dwordx2 v204, v[62:63], s[28:29] sc1
    s_mov_b32 exec_hi, -1
L_A_noml:
    v_mfma_f32_32x32x16_bf16 v[184:199], a[168:171], v[144:147], v[184:199]
    v_cvt_pk_bf16_f32 v216, v168, v169
    v_cvt_pk_bf16_f32 v217, v170, v171
    v_cvt_pk_bf16_f32 v218, v172, v173
    v_cvt_pk_bf16_f32 v219, v174, v175
    v_cvt_pk_bf16_f32 v220, v176, v177
    v_cvt_pk_bf16_f32 v221, v178, v179
    v_mfma_f32_32x32x16_bf16 v[184:199], a[172:175], v[148:151], v[184:199]
    v_cvt_pk_bf16_f32 v222, v180, v181
    v_cvt_pk_bf16_f32 v223, v182, v183
    s_nop 0
    v_permlane32_swap_b32 v216, v218
    v_permlane32_swap_b32 v217, v219
    v_permlane32_swap_b32 v220, v222
    v_mfma_f32_32x32x16_bf16 v[184:199], a[176:179], v[152:155], v[184:199]
    v_permlane32_swap_b32 v221, v223
    v_pk_min_u16 v216, v216, s65
    v_pk_min_u16 v217, v217, s65
    v_pk_min_u16 v218, v218, s65
    v_pk_min_u16 v219, v219, s65
    ds_write_b128 v224, v[216:219]
    v_mfma_f32_32x32x16_bf16 v[184:199], a[180:183], v[156:159], v[184:199]
    v_pk_min_u16 v220, v220, s65
    v_pk_min_u16 v221, v221, s65
    v_pk_min_u16 v222, v222, s65
    v_pk_min_u16 v223, v223, s65
    ds_write_b128 v225, v[220:223]
    v_mfma_f32_32x32x16_bf16 v[184:199], a[184:187], v[160:163], v[184:199]
    v_mfma_f32_32x32x16_bf16 v[184:199], a[188:191], v[164:167], v[184:199]
    v_mfma_f32_32x32x16_bf16 v[168:183], a[192:195], v[136:139], 0
    v_mfma_f32_32x32x16_bf16 v[168:183], a[196:199], v[140:143], v[168:183]
    v_mfma_f32_32x32x16_bf16 v[168:183], a[200:203], v[144:147], v[168:183]
    v_cvt_pk_bf16_f32 v216, v184, v185
    v_cvt_pk_bf16_f32 v217, v186, v187
    v_cvt_pk_bf16_f32 v218, v188, v189
    v_cvt_pk_bf16_f32 v219, v190, v191
    v_cvt_pk_bf16_f32 v220, v192, v193
    v_cvt_pk_bf16_f32 v221, v194, v195
    v_mfma_f32_32x32x16_bf16 v[168:183], a[204:207], v[148:151], v[168:183]
    v_cvt_pk_bf16_f32 v222, v196, v197
    v_cvt_pk_bf16_f32 v223, v198, v199
    s_nop 0
    v_permlane32_swap_b32 v216, v218
    v_permlane32_swap_b32 v217, v219
    v_permlane32_swap_b32 v220, v222
    v_mfma_f32_32x32x16_bf16 v[168:183], a[208:211], v[152:155], v[168:183]
    v_permlane32_swap_b32 v221, v223
    v_pk_min_u16 v216, v216, s65
    v_pk_min_u16 v217, v217, s65
    v_pk_min_u16 v218, v218, s65
    v_pk_min_u16 v219, v219, s65
    ds_write_b128 v226, v[216:219]
    v_mfma_f32_32x32x16_bf16 v[168:183], a[212:215], v[156:159], v[168:183]
    v_pk_min_u16 v220, v220, s65
    v_pk_min_u16 v221, v221, s65
    v_pk_min_u16 v222, v222, s65
    v_pk_min_u16 v223, v223, s65
    ds_write_b128 v227, v[220:223]
    v_mfma_f32_32x32x16_bf16 v[168:183], a[216:219], v[160:163], v[168:183]
    ds_read_b128 v[72:75], v232 offset:0
    ds_read_b128 v[76:79], v232 offset:1024
    ds_read_b128 v[80:83], v232 offset:2048
    ds_read_b128 v[84:87], v232 offset:3072
    v_mfma_f32_32x32x16_bf16 v[168:183], a[220:223], v[164:167], v[168:183]
    v_mfma_f32_32x32x16_bf16 v[184:199], a[224:227], v[136:139], 0
    s_waitcnt lgkmcnt(0)
    global_store_dwordx4 v233, v[72:75], s[28:29] offset:0 sc1
    global_store_dwordx4 v234, v[76:79], s[28:29] offset:0 sc1
    v_mfma_f32_32x32x16_bf16 v[184:199], a[228:231], v[140:143], v[184:199]
    global_store_dwordx4 v235, v[80:83], s[28:29] offset:0 sc1
    global_store_dwordx4 v236, v[84:87], s[28:29] offset:0 sc1
    v_mfma_f32_32x32x16_bf16 v[184:199], a[232:235], v[144:147], v[184:199]
    v_cvt_pk_bf16_f32 v216, v168, v169
    v_cvt_pk_bf16_f32 v217, v170, v171
    v_cvt_pk_bf16_f32 v218, v172, v173
    v_cvt_pk_bf16_f32 v219, v174, v175
    v_cvt_pk_bf16_f32 v220, v176, v177
    v_cvt_pk_bf16_f32 v221, v178, v179
    v_mfma_f32_32x32x16_bf16 v[184:199], a[236:239], v[148:151], v[184:199]
    v_cvt_pk_bf16_f32 v222, v180, v181
    v_cvt_pk_bf16_f32 v223, v182, v183
    s_nop 0
    v_permlane32_swap_b32 v216, v218
    v_permlane32_swap_b32 v217, v219
    v_permlane32_swap_b32 v220, v222
    v_mfma_f32_32x32x16_bf16 v[184:199], a[240:243], v[152:155], v[184:199]
    v_permlane32_swap_b32 v221, v223
    v_pk_min_u16 v216, v216, s65
    v_pk_min_u16 v217, v217, s65
    v_pk_min_u16 v218, v218, s65
    v_pk_min_u16 v219, v219, s65
    ds_write_b128 v224, v[216:219]
    v_mfma_f32_32x32x16_bf16 v[184:199], a[244:247], v[156:159], v[184:199]
    v_pk_min_u16 v220, v220, s65
    v_pk_min_u16 v221, v221, s65
    v_pk_min_u16 v222, v222, s65
    v_pk_min_u16 v223, v223, s65
    ds_write_b128 v225, v[220:223]
    v_mfma_f32_32x32x16_bf16 v[184:199], a[248:251], v[160:163], v[184:199]
    v_mfma_f32_32x32x16_bf16 v[184:199], a[252:255], v[164:167], v[184:199]
    s_nop 11
    v_cvt_pk_bf16_f32 v216, v184, v185
    v_cvt_pk_bf16_f32 v217, v186, v187
    v_cvt_pk_bf16_f32 v218, v188, v189
    v_cvt_pk_bf16_f32 v219, v190, v191
    v_cvt_pk_bf16_f32 v220, v192, v193
    v_cvt_pk_bf16_f32 v221, v194, v195
    v_cvt_pk_bf16_f32 v222, v196, v197
    v_cvt_pk_bf16_f32 v223, v198, v199
    s_nop 0
    v_permlane32_swap_b32 v216, v218
    v_permlane32_swap_b32 v217, v219
    v_permlane32_swap_b32 v220, v222
    v_permlane32_swap_b32 v221, v223
    v_pk_min_u16 v216, v216, s65
    v_pk_min_u16 v217, v217, s65
    v_pk_min_u16 v218, v218, s65
    v_pk_min_u16 v219, v219, s65
    ds_write_b128 v226, v[216:219]
    v_pk_min_u16 v220, v220, s65
    v_pk_min_u16 v221, v221, s65
    v_pk_min_u16 v222, v222, s65
    v_pk_min_u16 v223, v223, s65
    ds_write_b128 v227, v[220:223]
    ds_read_b128 v[72:75], v232 offset:0
    ds_read_b128 v[76:79], v232 offset:1024
    ds_read_b128 v[80:83], v232 offset:2048
    ds_read_b128 v[84:87], v232 offset:3072
    s_waitcnt lgkmcnt(3)
    global_store_dwordx4 v233, v[72:75], s[28:29] offset:128 sc1
    s_waitcnt lgkmcnt(2)
    global_store_dwordx4 v234, v[76:79], s[28:29] offset:128 sc1
    s_waitcnt lgkmcnt(1)
    global_store_dwordx4 v235, v[80:83], s[28:29] offset:128 sc1
    s_waitcnt lgkmcnt(0)
    global_store_dwordx4 v236, v[84:87], s[28:29] offset:128 sc1
    s_barrier
    s_cmp_ge_u32 s49, 24
    s_cbranch_scc1 L_S7
    s_cmp_ge_u32 s49, 22
    s_cbranch_scc1 L_end
    v_lshrrev_b32 v5, 4, v0
    v_and_b32 v6, 15, v0
    v_lshrrev_b32 v16, 3, v0
    v_mul_u32_u24 v18, 2752, v16
    v_bfe_u32 v16, v0, 4, 1
    v_bfe_u32 v17, v0, 1, 2
    v_xor_b32 v17, v17, v16
    v_lshl_add_u32 v18, v17, 5, v18
    v_and_b32 v16, 1, v0
    v_lshl_add_u32 v8, v16, 4, v18
    v_xor_b32 v17, 2, v17
    v_lshrrev_b32 v16, 3, v0
    v_mul_u32_u24 v18, 2752, v16
    v_lshl_add_u32 v18, v17, 5, v18
    v_and_b32 v16, 1, v0
    v_lshl_add_u32 v9, v16, 4, v18
    s_lshl_b32 s51, s49, 7
    s_sub_u32 s52, 1409024, s51
    s_mov_b32 s36, s18
    s_mov_b32 s37, s19
    s_add_u32 s36, s36, s51
    s_addc_u32 s37, s37, 0
    s_mov_b32 s38, 0x0
    s_mov_b32 s39, 0x20000
    s_mov_b32 s38, s52
    s_mov_b32 s40, s20
    s_mov_b32 s41, s21
    s_add_u32 s40, s40, s51
    s_addc_u32 s41, s41, 0
    s_mov_b32 s42, 0x0
    s_mov_b32 s43, 0x20000
    s_mov_b32 s42, s52
    s_mul_i32 s53, s33, 352256
    s_mov_b32 s46, s52
    s_mov_b32 s47, 0x20000
    s_add_u32 s51, s48, 0
    s_and_b32 s52, s51, 1
    s_bitcmp1_b32 s51, 1
    s_cselect_b32 s44, s40, s36
    s_cselect_b32 s45, s41, s37
    s_cselect_b32 s54, 0x10000, 0
    s_lshl_b32 s51, s33, 14
    s_add_u32 s54, s54, s51
    s_lshl_b32 s51, s52, 13
    s_add_u32 m0, s54, s51
    s_mul_i32 s52, s52, 176128
    s_add_u32 s50, s53, s52
    buffer_load_dwordx4 v8, s[44:47], s50 offen lds
    s_add_u32 m0, m0, 0x400
    s_add_u32 s50, s50, 22016
    buffer_load_dwordx4 v9, s[44:47], s50 offen lds
    s_add_u32 m0, m0, 0x400
    s_add_u32 s50, s50, 22016
    buffer_load_dwordx4 v8, s[44:47], s50 offen lds
    s_add_u32 m0, m0, 0x400
    s_add_u32 s50, s50, 22016
    buffer_load_dwordx4 v9, s[44:47], s50 offen lds
    s_add_u32 m0, m0, 0x400
    s_add_u32 s50, s50, 22016
    buffer_load_dwordx4 v8, s[44:47], s50 offen lds
    s_add_u32 m0, m0, 0x400
    s_add_u32 s50, s50, 22016
    buffer_load_dwordx4 v9, s[44:47], s50 offen lds
    s_add_u32 m0, m0, 0x400
    s_add_u32 s50, s50, 22016
    buffer_load_dwordx4 v8, s[44:47], s50 offen lds
    s_add_u32 m0, m0, 0x400
    s_add_u32 s50, s50, 22016
    buffer_load_dwordx4 v9, s[44:47], s50 offen lds
    s_add_u32 s51, s48, 1
    s_and_b32 s52, s51, 1
    s_bitcmp1_b32 s51, 1
    s_cselect_b32 s44, s40, s36
    s_cselect_b32 s45, s41, s37
    s_cselect_b32 s54, 0x10000, 0
    s_lshl_b32 s51, s33, 14
    s_add_u32 s54, s54, s51
    s_lshl_b32 s51, s52, 13
    s_add_u32 m0, s54, s51
    s_mul_i32 s52, s52, 176128
    s_add_u32 s50, s53, s52
    buffer_load_dwordx4 v8, s[44:47], s50 offen lds
    s_add_u32 m0, m0, 0x400
    s_add_u32 s50, s50, 22016
    buffer_load_dwordx4 v9, s[44:47], s50 offen lds
    s_add_u32 m0, m0, 0x400
    s_add_u32 s50, s50, 22016
    buffer_load_dwordx4 v8, s[44:47], s50 offen lds
    s_add_u32 m0, m0, 0x400
    s_add_u32 s50, s50, 22016
    buffer_load_dwordx4 v9, s[44:47], s50 offen lds
    s_add_u32 m0, m0, 0x400
    s_add_u32 s50, s50, 22016
    buffer_load_dwordx4 v8, s[44:47], s50 offen lds
    s_add_u32 m0, m0, 0x400
    s_add_u32 s50, s50, 22016
    buffer_load_dwordx4 v9, s[44:47], s50 offen lds
    s_add_u32 m0, m0, 0x400
    s_add_u32 s50, s50, 22016
    buffer_load_dwordx4 v8, s[44:47], s50 offen lds
    s_add_u32 m0, m0, 0x400
    s_add_u32 s50, s50, 22016
    buffer_load_dwordx4 v9, s[44:47], s50 offen lds
    s_add_u32 s51, s48, 2
    s_and_b32 s52, s51, 1
    s_bitcmp1_b32 s51, 1
    s_cselect_b32 s44, s40, s36
    s_cselect_b32 s45, s41, s37
    s_cselect_b32 s54, 0x10000, 0
    s_lshl_b32 s51, s33, 14
    s_add_u32 s54, s54, s51
    s_lshl_b32 s51, s52, 13
    s_add_u32 m0, s54, s51
    s_mul_i32 s52, s52, 176128
    s_add_u32 s50, s53, s52
    buffer_load_dwordx4 v8, s[44:47], s50 offen lds
    s_add_u32 m0, m0, 0x400
    s_add_u32 s50, s50, 22016
    buffer_load_dwordx4 v9, s[44:47], s50 offen lds
    s_add_u32 m0, m0, 0x400
    s_add_u32 s50, s50, 22016
    buffer_load_dwordx4 v8, s[44:47], s50 offen lds
    s_add_u32 m0, m0, 0x400
    s_add_u32 s50, s50, 22016
    buffer_load_dwordx4 v9, s[44:47], s50 offen lds
    s_add_u32 m0, m0, 0x400
    s_add_u32 s50, s50, 22016
    buffer_load_dwordx4 v8, s[44:47], s50 offen lds
    s_add_u32 m0, m0, 0x400
    s_add_u32 s50, s50, 22016
    buffer_load_dwordx4 v9, s[44:47], s50 offen lds
    s_add_u32 m0, m0, 0x400
    s_add_u32 s50, s50, 22016
    buffer_load_dwordx4 v8, s[44:47], s50 offen lds
    s_add_u32 m0, m0, 0x400
    s_add_u32 s50, s50, 22016
    buffer_load_dwordx4 v9, s[44:47], s50 offen lds
    s_add_u32 s51, s48, 3
    s_and_b32 s52, s51, 1
    s_bitcmp1_b32 s51, 1
    s_cselect_b32 s44, s40, s36
    s_cselect_b32 s45, s41, s37
    s_cselect_b32 s54, 0x10000, 0
    s_lshl_b32 s51, s33, 14
    s_add_u32 s54, s54, s51
    s_lshl_b32 s51, s52, 13
    s_add_u32 m0, s54, s51
    s_mul_i32 s52, s52, 176128
    s_add_u32 s50, s53, s52
    buffer_load_dwordx4 v8, s[44:47], s50 offen lds
    s_add_u32 m0, m0, 0x400
    s_add_u32 s50, s50, 22016
    buffer_load_dwordx4 v9, s[44:47], s50 offen lds
    s_add_u32 m0, m0, 0x400
    s_add_u32 s50, s50, 22016
    buffer_load_dwordx4 v8, s[44:47], s50 offen lds
    s_add_u32 m0, m0, 0x400
    s_add_u32 s50, s50, 22016
    buffer_load_dwordx4 v9, s[44:47], s50 offen lds
    s_add_u32 m0, m0, 0x400
    s_add_u32 s50, s50, 22016
    buffer_load_dwordx4 v8, s[44:47], s50 offen lds
    s_add_u32 m0, m0, 0x400
    s_add_u32 s50, s50, 22016
    buffer_load_dwordx4 v9, s[44:47], s50 offen lds
    s_add_u32 m0, m0, 0x400
    s_add_u32 s50, s50, 22016
    buffer_load_dwordx4 v8, s[44:47], s50 offen lds
    s_add_u32 m0, m0, 0x400
    s_add_u32 s50, s50, 22016
    buffer_load_dwordx4 v9, s[44:47], s50 offen lds
    s_lshl_b32 s51, s48, 10
    s_lshl_b32 s52, s33, 8
    s_add_u32 s51, s51, s52
    v_lshlrev_b32 v10, 1, v0
    v_add_u32 v10, s51, v10
    global_load_ushort v12, v10, s[4:5]
    global_load_ushort v13, v10, s[4:5] offset:128
    v_lshrrev_b32 v16, 4, v0
    v_bfe_u32 v17, v0, 1, 3
    v_xor_b32 v17, v17, v16
    v_lshlrev_b32 v17, 5, v17
    v_lshl_add_u32 v17, v16, 10, v17
    v_and_b32 v16, 1, v0
    v_lshl_add_u32 v14, v16, 4, v17
    v_xor_b32 v15, 128, v14
    v_lshrrev_b32 v16, 2, v6
    v_and_b32 v17, 1, v5
    v_lshl_or_b32 v17, v17, 2, v16
    v_lshlrev_b32 v17, 5, v17
    v_lshl_add_u32 v16, v5, 3, v16
    v_lshl_add_u32 v17, v16, 8, v17
    v_and_b32 v16, 3, v6
    v_lshl_add_u32 v17, v16, 3, v17
    s_lshl_b32 s51, s33, 13
    s_add_u32 s51, s51, 131072
    v_add_u32 v20, s51, v17
    v_xor_b32 v21, 32, v20
    v_xor_b32 v22, 64, v20
    v_xor_b32 v23, 96, v20
    v_xor_b32 v24, 128, v20
    v_xor_b32 v25, 160, v20
    v_xor_b32 v26, 192, v20
    v_xor_b32 v27, 224, v20
    v_lshrrev_b32 v16, 2, v6
    v_lshrrev_b32 v17, 1, v16
    v_and_b32 v18, 1, v5
    v_lshl_or_b32 v17, v18, 1, v17
    v_xor_b32 v17, s33, v17
    v_lshlrev_b32 v17, 5, v17
    v_lshl_add_u32 v16, v5, 3, v16
    v_lshl_add_u32 v17, v16, 7, v17
    v_and_b32 v16, 3, v6
    v_lshl_add_u32 v28, v16, 3, v17
    v_add_u32 v29, 0x10000, v28
    s_lshl_b32 s51, s48, 15
    s_lshl_b32 s52, s33, 8
    s_add_u32 s51, s51, s52
    s_mov_b32 s44, s28
    s_mov_b32 s45, s29
    s_add_u32 s44, s44, s51
    s_addc_u32 s45, s45, 0
    s_add_u32 s44, s44, 0x30000
    s_addc_u32 s45, s45, 0
    s_mov_b32 s46, 0x8000
    s_mov_b32 s47, 0x20000
    s_lshl_b32 s54, s33, 13
    s_add_u32 s54, s54, 131072
    v_bfe_u32 v17, v0, 1, 1
    v_mul_u32_u24 v16, 576, v17
    v_lshrrev_b32 v17, 2, v0
    v_lshl_add_u32 v16, v17, 2, v16
    v_and_b32 v17, 1, v0
    v_lshl_add_u32 v16, v17, 1, v16
    s_lshl_b32 s51, s33, 7
    v_add_u32 v30, s51, v16
    v_mul_u32_u24 v16, 576, v17
    v_lshl_add_u32 v31, v5, 4, v16
    v_lshrrev_b32 v16, 5, v0
    v_mul_u32_u24 v16, 576, v16
    v_and_b32 v18, 31, v0
    v_lshl_add_u32 v40, v18, 4, v16
    v_mov_b32 v41, 0x4444
    v_mov_b32 v16, 0xeeee
    v_cmp_eq_u32 vcc, 1, v17
    s_nop 1
    v_cndmask_b32 v41, v41, v16, vcc
    s_mul_i32 s51, s48, 2816
    s_lshl_b32 s52, s49, 7
    s_add_u32 s51, s51, s52
    s_add_u32 s51, s51, 0x50000
    v_and_b32 v16, 31, v0
    v_lshlrev_b32 v16, 2, v16
    v_add_u32 v19, s51, v16
    v_add_u32 v35, 2048, v16
    s_lshl_b32 s51, s33, 5
    s_add_u32 s51, s51, 2048
    v_lshlrev_b32 v16, 1, v6
    v_add_u32 v32, s51, v16
    v_mov_b32 v36, 0x3f803f80
    v_mov_b32 v37, 0x3f803f80
    v_mov_b32 v38, 0x3f803f80
    v_mov_b32 v39, 0x3f803f80
    s_waitcnt vmcnt(0)
    v_lshlrev_b32 v12, 16, v12
    v_lshlrev_b32 v13, 16, v13
    s_barrier
    ds_read_b64_tr_b16 a[0:1], v28 offset:0
    ds_read_b64_tr_b16 a[2:3], v28 offset:512
    ds_read_b64_tr_b16 a[4:5], v28 offset:4096
    ds_read_b64_tr_b16 a[6:7], v28 offset:4608
    ds_read_b64_tr_b16 a[8:9], v28 offset:8192
    ds_read_b64_tr_b16 a[10:11], v28 offset:8704
    ds_read_b64_tr_b16 a[12:13], v28 offset:12288
    ds_read_b64_tr_b16 a[14:15], v28 offset:12800
    ds_read_b64_tr_b16 a[16:17], v28 offset:16384
    ds_read_b64_tr_b16 a[18:19], v28 offset:16896
    ds_read_b64_tr_b16 a[20:21], v28 offset:20480
    ds_read_b64_tr_b16 a[22:23], v28 offset:20992
    ds_read_b64_tr_b16 a[24:25], v28 offset:24576
    ds_read_b64_tr_b16 a[26:27], v28 offset:25088
    ds_read_b64_tr_b16 a[28:29], v28 offset:28672
    ds_read_b64_tr_b16 a[30:31], v28 offset:29184
    ds_read_b64_tr_b16 a[32:33], v28 offset:32768
    ds_read_b64_tr_b16 a[34:35], v28 offset:33280
    ds_read_b64_tr_b16 a[36:37], v28 offset:36864
    ds_read_b64_tr_b16 a[38:39], v28 offset:37376
    ds_read_b64_tr_b16 a[40:41], v28 offset:40960
    ds_read_b64_tr_b16 a[42:43], v28 offset:41472
    ds_read_b64_tr_b16 a[44:45], v28 offset:45056
    ds_read_b64_tr_b16 a[46:47], v28 offset:45568
    ds_read_b64_tr_b16 a[48:49], v28 offset:49152
    ds_read_b64_tr_b16 a[50:51], v28 offset:49664
    ds_read_b64_tr_b16 a[52:53], v28 offset:53248
    ds_read_b64_tr_b16 a[54:55], v28 offset:53760
    ds_read_b64_tr_b16 a[56:57], v28 offset:57344
    ds_read_b64_tr_b16 a[58:59], v28 offset:57856
    ds_read_b64_tr_b16 a[60:61], v28 offset:61440
    ds_read_b64_tr_b16 a[62:63], v28 offset:61952
    ds_read_b64_tr_b16 a[64:65], v29 offset:0
    ds_read_b64_tr_b16 a[66:67], v29 offset:512
    ds_read_b64_tr_b16 a[68:69], v29 offset:4096
    ds_read_b64_tr_b16 a[70:71], v29 offset:4608
    ds_read_b64_tr_b16 a[72:73], v29 offset:8192
    ds_read_b64_tr_b16 a[74:75], v29 offset:8704
    ds_read_b64_tr_b16 a[76:77], v29 offset:12288
    ds_read_b64_tr_b16 a[78:79], v29 offset:12800
    ds_read_b64_tr_b16 a[80:81], v29 offset:16384
    ds_read_b64_tr_b16 a[82:83], v29 offset:16896
    ds_read_b64_tr_b16 a[84:85], v29 offset:20480
    ds_read_b64_tr_b16 a[86:87], v29 offset:20992
    ds_read_b64_tr_b16 a[88:89], v29 offset:24576
    ds_read_b64_tr_b16 a[90:91], v29 offset:25088
    ds_read_b64_tr_b16 a[92:93], v29 offset:28672
    ds_read_b64_tr_b16 a[94:95], v29 offset:29184
    ds_read_b64_tr_b16 a[96:97], v29 offset:32768
    ds_read_b64_tr_b16 a[98:99], v29 offset:33280
    ds_read_b64_tr_b16 a[100:101], v29 offset:36864
    ds_read_b64_tr_b16 a[102:103], v29 offset:37376
    ds_read_b64_tr_b16 a[104:105], v29 offset:40960
    ds_read_b64_tr_b16 a[106:107], v29 offset:41472
    ds_read_b64_tr_b16 a[108:109], v29 offset:45056
    ds_read_b64_tr_b16 a[110:111], v29 offset:45568
    ds_read_b64_tr_b16 a[112:113], v29 offset:49152
    ds_read_b64_tr_b16 a[114:115], v29 offset:49664
    ds_read_b64_tr_b16 a[116:117], v29 offset:53248
    ds_read_b64_tr_b16 a[118:119], v29 offset:53760
    ds_read_b64_tr_b16 a[120:121], v29 offset:57344
    ds_read_b64_tr_b16 a[122:123], v29 offset:57856
    ds_read_b64_tr_b16 a[124:125], v29 offset:61440
    ds_read_b64_tr_b16 a[126:127], v29 offset:61952
    s_waitcnt lgkmcnt(0)
    s_barrier
    v_mfma_f32_16x16x32_bf16 v[176:179], v[36:39], a[0:3], 0
    v_mfma_f32_16x16x32_bf16 v[180:183], v[36:39], a[64:67], 0
    v_mfma_f32_16x16x32_bf16 v[176:179], v[36:39], a[4:7], v[176:179]
    v_mfma_f32_16x16x32_bf16 v[180:183], v[36:39], a[68:71], v[180:183]
    v_mfma_f32_16x16x32_bf16 v[176:179], v[36:39], a[8:11], v[176:179]
    v_mfma_f32_16x16x32_bf16 v[180:183], v[36:39], a[72:75], v[180:183]
    v_mfma_f32_16x16x32_bf16 v[176:179], v[36:39], a[12:15], v[176:179]
    v_mfma_f32_16x16x32_bf16 v[180:183], v[36:39], a[76:79], v[180:183]
    v_mfma_f32_16x16x32_bf16 v[176:179], v[36:39], a[16:19], v[176:179]
    v_mfma_f32_16x16x32_bf16 v[180:183], v[36:39], a[80:83], v[180:183]
    v_mfma_f32_16x16x32_bf16 v[176:179], v[36:39], a[20:23], v[176:179]
    v_mfma_f32_16x16x32_bf16 v[180:183], v[36:39], a[84:87], v[180:183]
    v_mfma_f32_16x16x32_bf16 v[176:179], v[36:39], a[24:27], v[176:179]
    v_mfma_f32_16x16x32_bf16 v[180:183], v[36:39], a[88:91], v[180:183]
    v_mfma_f32_16x16x32_bf16 v[176:179], v[36:39], a[28:31], v[176:179]
    v_mfma_f32_16x16x32_bf16 v[180:183], v[36:39], a[92:95], v[180:183]
    v_mfma_f32_16x16x32_bf16 v[176:179], v[36:39], a[32:35], v[176:179]
    v_mfma_f32_16x16x32_bf16 v[180:183], v[36:39], a[96:99], v[180:183]
    v_mfma_f32_16x16x32_bf16 v[176:179], v[36:39], a[36:39], v[176:179]
    v_mfma_f32_16x16x32_bf16 v[180:183], v[36:39], a[100:103], v[180:183]
    v_mfma_f32_16x16x32_bf16 v[176:179], v[36:39], a[40:43], v[176:179]
    v_mfma_f32_16x16x32_bf16 v[180:183], v[36:39], a[104:107], v[180:183]
    v_mfma_f32_16x16x32_bf16 v[176:179], v[36:39], a[44:47], v[176:179]
    v_mfma_f32_16x16x32_bf16 v[180:183], v[36:39], a[108:111], v[180:183]
    v_mfma_f32_16x16x32_bf16 v[176:179], v[36:39], a[48:51], v[176:179]
    v_mfma_f32_16x16x32_bf16 v[180:183], v[36:39], a[112:115], v[180:183]
    v_mfma_f32_16x16x32_bf16 v[176:179], v[36:39], a[52:55], v[176:179]
    v_mfma_f32_16x16x32_bf16 v[180:183], v[36:39], a[116:119], v[180:183]
    v_mfma_f32_16x16x32_bf16 v[176:179], v[36:39], a[56:59], v[176:179]
    v_mfma_f32_16x16x32_bf16 v[180:183], v[36:39], a[120:123], v[180:183]
    v_mfma_f32_16x16x32_bf16 v[176:179], v[36:39], a[60:63], v[176:179]
    v_mfma_f32_16x16x32_bf16 v[180:183], v[36:39], a[124:127], v[180:183]
    v_mov_b32 v56, 0
    v_mov_b32 v57, 0
    v_mov_b32 v58, 0
    v_mov_b32 v59, 0
    v_mov_b32 v60, 0
    v_mov_b32 v61, 0
    v_mov_b32 v62, 0
    v_mov_b32 v63, 0
L_S6_g:
    s_mov_b32 m0, s54
    s_mov_b32 s50, 0
    buffer_load_dwordx4 v14, s[44:47], s50 offen sc1 lds
    s_add_u32 m0, m0, 0x400
    s_add_u32 s50, s50, 0x1000
    buffer_load_dwordx4 v14, s[44:47], s50 offen sc1 lds
    s_add_u32 m0, m0, 0x400
    s_add_u32 s50, s50, 0x1000
    buffer_load_dwordx4 v15, s[44:47], s50 offen sc1 lds
    s_add_u32 m0, m0, 0x400
    s_add_u32 s50, s50, 0x1000
    buffer_load_dwordx4 v15, s[44:47], s50 offen sc1 lds
    s_add_u32 m0, m0, 0x400
    s_add_u32 s50, s50, 0x1000
    buffer_load_dwordx4 v14, s[44:47], s50 offen sc1 lds
    s_add_u32 m0, m0, 0x400
    s_add_u32 s50, s50, 0x1000
    buffer_load_dwordx4 v14, s[44:47], s50 offen sc1 lds
    s_add_u32 m0, m0, 0x400
    s_add_u32 s50, s50, 0x1000
    buffer_load_dwordx4 v15, s[44:47], s50 offen sc1 lds
    s_add_u32 m0, m0, 0x400
    s_add_u32 s50, s50, 0x1000
    buffer_load_dwordx4 v15, s[44:47], s50 offen sc1 lds
L_S6_chk:
    s_waitcnt vmcnt(0)
    ds_read_b64_tr_b16 v[64:65], v20 offset:0
    ds_read_b64_tr_b16 v[66:67], v20 offset:1024
    ds_read_b64_tr_b16 v[68:69], v21 offset:0
    ds_read_b64_tr_b16 v[70:71], v21 offset:1024
    ds_read_b64_tr_b16 v[72:73], v22 offset:0
    ds_read_b64_tr_b16 v[74:75], v22 offset:1024
    ds_read_b64_tr_b16 v[76:77], v23 offset:0
    ds_read_b64_tr_b16 v[78:79], v23 offset:1024
    ds_read_b64_tr_b16 v[80:81], v24 offset:0
    ds_read_b64_tr_b16 v[82:83], v24 offset:1024
    ds_read_b64_tr_b16 v[84:85], v25 offset:0
    ds_read_b64_tr_b16 v[86:87], v25 offset:1024
    ds_read_b64_tr_b16 v[88:89], v26 offset:0
    ds_read_b64_tr_b16 v[90:91], v26 offset:1024
    ds_read_b64_tr_b16 v[92:93], v27 offset:0
    ds_read_b64_tr_b16 v[94:95], v27 offset:1024
    s_waitcnt lgkmcnt(14)
    v_mfma_f32_16x16x32_bf16 v[96:99], v[36:39], v[64:67], 0
    v_pk_max_u16 v33, v64, v65
    v_pk_max_u16 v34, v66, v67
    s_waitcnt lgkmcnt(12)
    v_mfma_f32_16x16x32_bf16 v[100:103], v[36:39], v[68:71], 0
    v_pk_max_u16 v33, v33, v68
    v_pk_max_u16 v33, v33, v69
    v_pk_max_u16 v34, v34, v70
    v_pk_max_u16 v34, v34, v71
    s_waitcnt lgkmcnt(10)
    v_mfma_f32_16x16x32_bf16 v[104:107], v[36:39], v[72:75], 0
    v_pk_max_u16 v33, v33, v72
    v_pk_max_u16 v33, v33, v73
    v_pk_max_u16 v34, v34, v74
    v_pk_max_u16 v34, v34, v75
    s_waitcnt lgkmcnt(8)
    v_mfma_f32_16x16x32_bf16 v[108:111], v[36:39], v[76:79], 0
    v_pk_max_u16 v33, v33, v76
    v_pk_max_u16 v33, v33, v77
    v_pk_max_u16 v34, v34, v78
    v_pk_max_u16 v34, v34, v79
    s_waitcnt lgkmcnt(6)
    v_mfma_f32_16x16x32_bf16 v[112:115], v[36:39], v[80:83], 0
    v_pk_max_u16 v33, v33, v80
    v_pk_max_u16 v33, v33, v81
    v_pk_max_u16 v34, v34, v82
    v_pk_max_u16 v34, v34, v83
    s_waitcnt lgkmcnt(4)
    v_mfma_f32_16x16x32_bf16 v[116:119], v[36:39], v[84:87], 0
    v_pk_max_u16 v33, v33, v84
    v_pk_max_u16 v33, v33, v85
    v_pk_max_u16 v34, v34, v86
    v_pk_max_u16 v34, v34, v87
    s_waitcnt lgkmcnt(2)
    v_mfma_f32_16x16x32_bf16 v[120:123], v[36:39], v[88:91], 0
    v_pk_max_u16 v33, v33, v88
    v_pk_max_u16 v33, v33, v89
    v_pk_max_u16 v34, v34, v90
    v_pk_max_u16 v34, v34, v91
    s_waitcnt lgkmcnt(0)
    v_mfma_f32_16x16x32_bf16 v[124:127], v[36:39], v[92:95], 0
    v_pk_max_u16 v33, v33, v92
    v_pk_max_u16 v33, v33, v93
    v_pk_max_u16 v34, v34, v94
    v_pk_max_u16 v34, v34, v95
    v_lshlrev_b32 v42, 16, v33
    v_lshlrev_b32 v43, 16, v34
    v_max_u32 v33, v33, v42
    v_max_u32 v34, v34, v43
    s_mov_b32 s51, 0xffff0000
    v_cmp_le_u32 s[66:67], s51, v33
    v_cmp_le_u32 s[68:69], s51, v34
    s_nop 3
    s_or_b64 vcc, s[66:67], s[68:69]
    s_cbranch_scc0 L_S6_ok
    s_sleep 2
    s_add_u32 s55, s55, 1
    s_cmp_gt_u32 s55, 0x40000
    s_cbranch_scc1 L_fail
    s_bfe_u32 s51, s66, 0x100000
    s_cbranch_scc0 L_S6_r_0
    s_add_u32 m0, s54, 0
    s_movk_i32 s50, 0
    buffer_load_dwordx4 v14, s[44:47], s50 offen sc1 lds
L_S6_r_0:
    s_bfe_u32 s51, s68, 0x100000
    s_cbranch_scc0 L_S6_r_1
    s_add_u32 m0, s54, 1024
    s_movk_i32 s50, 4096
    buffer_load_dwordx4 v14, s[44:47], s50 offen sc1 lds
L_S6_r_1:
    s_bfe_u32 s51, s66, 0x100010
    s_cbranch_scc0 L_S6_r_2
    s_add_u32 m0, s54, 2048
    s_movk_i32 s50, 8192
    buffer_load_dwordx4 v15, s[44:47], s50 offen sc1 lds
L_S6_r_2:
    s_bfe_u32 s51, s68, 0x100010
    s_cbranch_scc0 L_S6_r_3
    s_add_u32 m0, s54, 3072
    s_movk_i32 s50, 12288
    buffer_load_dwordx4 v15, s[44:47], s50 offen sc1 lds
L_S6_r_3:
    s_bfe_u32 s51, s67, 0x100000
    s_cbranch_scc0 L_S6_r_4
    s_add_u32 m0, s54, 4096
    s_movk_i32 s50, 16384
    buffer_load_dwordx4 v14, s[44:47], s50 offen sc1 lds
L_S6_r_4:
    s_bfe_u32 s51, s69, 0x100000
    s_cbranch_scc0 L_S6_r_5
    s_add_u32 m0, s54, 5120
    s_movk_i32 s50, 20480
    buffer_load_dwordx4 v14, s[44:47], s50 offen sc1 lds
L_S6_r_5:
    s_bfe_u32 s51, s67, 0x100010
    s_cbranch_scc0 L_S6_r_6
    s_add_u32 m0, s54, 6144
    s_movk_i32 s50, 24576
    buffer_load_dwordx4 v15, s[44:47], s50 offen sc1 lds
L_S6_r_6:
    s_bfe_u32 s51, s69, 0x100010
    s_cbranch_scc0 L_S6_r_7
    s_add_u32 m0, s54, 7168
    s_movk_i32 s50, 28672
    buffer_load_dwordx4 v15, s[44:47], s50 offen sc1 lds
L_S6_r_7:
    s_branch L_S6_chk
L_S6_ok:
    s_nop 2
    v_mov_b32_dpp v96, v100 quad_perm:[0,1,2,3] row_mask:0x2 bank_mask:0xf
    v_mov_b32_dpp v112, v116 quad_perm:[0,1,2,3] row_mask:0x2 bank_mask:0xf
    v_mov_b32_dpp v96, v104 quad_perm:[0,1,2,3] row_mask:0x4 bank_mask:0xf
    v_mov_b32_dpp v112, v120 quad_perm:[0,1,2,3] row_mask:0x4 bank_mask:0xf
    v_mov_b32_dpp v96, v108 quad_perm:[0,1,2,3] row_mask:0x8 bank_mask:0xf
    v_mov_b32_dpp v112, v124 quad_perm:[0,1,2,3] row_mask:0x8 bank_mask:0xf
    v_add_f32 v96, v96, v12
    v_add_f32 v112, v112, v13
    v_cvt_pk_bf16_f32 v96, v96, v96
    v_cvt_pk_bf16_f32 v112, v112, v112
    ds_write_b16 v30, v96
    ds_write_b16 v30, v112 offset:64
    s_waitcnt lgkmcnt(0)
    s_barrier
    ds_read_b128 v[44:47], v40
    ds_read_b128 v[128:131], v31 offset:0
    ds_read_b128 v[132:135], v31 offset:64
    ds_read_b128 v[136:139], v31 offset:128
    ds_read_b128 v[140:143], v31 offset:192
    ds_read_b128 v[144:147], v31 offset:256
    ds_read_b128 v[148:151], v31 offset:320
    ds_read_b128 v[152:155], v31 offset:384
    ds_read_b128 v[156:159], v31 offset:448
    s_waitcnt lgkmcnt(7)
    v_smfmac_f32_16x16x64_bf16 v[56:59], v[128:131], a[0:7], v41
    v_lshlrev_b32 v48, 16, v44
    v_and_b32 v49, 0xffff0000, v44
    v_lshlrev_b32 v50, 16, v45
    v_smfmac_f32_16x16x64_bf16 v[60:63], v[128:131], a[64:71], v41
    v_and_b32 v51, 0xffff0000, v45
    v_lshlrev_b32 v52, 16, v46
    v_and_b32 v53, 0xffff0000, v46
    s_waitcnt lgkmcnt(6)
    v_smfmac_f32_16x16x64_bf16 v[56:59], v[132:135], a[8:15], v41
    v_lshlrev_b32 v54, 16, v47
    v_and_b32 v55, 0xffff0000, v47
    v_add_f32 v64, v48, v49
    v_smfmac_f32_16x16x64_bf16 v[60:63], v[132:135], a[72:79], v41
    v_mul_f32 v65, v48, v48
    v_add_f32 v66, v50, v51
    v_mul_f32 v67, v49, v49
    s_waitcnt lgkmcnt(5)
    v_smfmac_f32_16x16x64_bf16 v[56:59], v[136:139], a[16:23], v41
    v_add_f32 v68, v52, v53
    v_fmac_f32 v65, v50, v50
    v_add_f32 v69, v54, v55
    v_smfmac_f32_16x16x64_bf16 v[60:63], v[136:139], a[80:87], v41
    v_fmac_f32 v67, v51, v51
    v_add_f32 v64, v64, v66
    v_fmac_f32 v65, v52, v52
    s_waitcnt lgkmcnt(4)
    v_smfmac_f32_16x16x64_bf16 v[56:59], v[140:143], a[24:31], v41
    v_add_f32 v68, v68, v69
    v_fmac_f32 v67, v53, v53
    v_add_f32 v64, v64, v68
    v_smfmac_f32_16x16x64_bf16 v[60:63], v[140:143], a[88:95], v41
    v_fmac_f32 v65, v54, v54
    v_fmac_f32 v67, v55, v55
    v_add_f32 v65, v65, v67
    s_waitcnt lgkmcnt(3)
    v_smfmac_f32_16x16x64_bf16 v[56:59], v[144:147], a[32:39], v41
    s_nop 0
    v_add_f32_dpp v64, v64, v64 quad_perm:[1,0,3,2] row_mask:0xf bank_mask:0xf
    v_add_f32_dpp v65, v65, v65 quad_perm:[1,0,3,2] row_mask:0xf bank_mask:0xf
    v_smfmac_f32_16x16x64_bf16 v[60:63], v[144:147], a[96:103], v41
    s_nop 0
    v_add_f32_dpp v64, v64, v64 quad_perm:[2,3,0,1] row_mask:0xf bank_mask:0xf
    v_add_f32_dpp v65, v65, v65 quad_perm:[2,3,0,1] row_mask:0xf bank_mask:0xf
    s_waitcnt lgkmcnt(2)
    v_smfmac_f32_16x16x64_bf16 v[56:59], v[148:151], a[40:47], v41
    s_nop 0
    v_add_f32_dpp v64, v64, v64 row_half_mirror row_mask:0xf bank_mask:0xf
    v_add_f32_dpp v65, v65, v65 row_half_mirror row_mask:0xf bank_mask:0xf
    v_smfmac_f32_16x16x64_bf16 v[60:63], v[148:151], a[104:111], v41
    s_nop 0
    v_add_f32_dpp v64, v64, v64 row_mirror row_mask:0xf bank_mask:0xf
    v_add_f32_dpp v65, v65, v65 row_mirror row_mask:0xf bank_mask:0xf
    s_waitcnt lgkmcnt(1)
    v_smfmac_f32_16x16x64_bf16 v[56:59], v[152:155], a[48:55], v41
    v_mov_b32 v66, v64
    v_mov_b32 v67, v65
    s_nop 0
    v_smfmac_f32_16x16x64_bf16 v[60:63], v[152:155], a[112:119], v41
    v_permlane16_swap_b32 v64, v66
    v_permlane16_swap_b32 v65, v67
    v_add_f32 v64, v64, v66
    s_waitcnt lgkmcnt(0)
    v_smfmac_f32_16x16x64_bf16 v[56:59], v[156:159], a[56:63], v41
    v_add_f32 v65, v65, v67
    v_mov_b32 v66, v64
    v_mov_b32 v67, v65
    v_smfmac_f32_16x16x64_bf16 v[60:63], v[156:159], a[120:127], v41
    s_nop 0
    v_permlane32_swap_b32 v64, v66
    v_permlane32_swap_b32 v65, v67
    v_add_f32 v64, v64, v66
    v_add_f32 v65, v65, v67
    v_mul_f32 v64, 0x3b000000, v64
    v_mul_f32 v65, 0x3b000000, v65
    v_fma_f32 v65, -v64, v64, v65
    v_max_f32 v65, 0, v65
    v_add_f32 v65, 0x3727c5ac, v65
    v_rsq_f32 v65, v65
    s_nop 3
    v_add_f32 v56, v56, v57
    v_add_f32 v60, v60, v61
    v_fma_f32 v56, -v64, v176, v56
    v_fma_f32 v60, -v64, v180, v60
    v_mul_f32 v56, v56, v65
    v_mul_f32 v60, v60, v65
    v_max_f32 v56, 0, v56
    v_mul_f32 v56, v56, v60
    v_cvt_pk_bf16_f32 v56, v56, v56
    ds_write_b16 v32, v56
    s_waitcnt lgkmcnt(0)
    s_barrier
    s_cmp_lg_u32 s33, 0
    s_cbranch_scc1 L_end
    ds_read_b32 v56, v35
    s_mov_b32 s51, 0xfffefffe
    s_mov_b32 exec_hi, 0
    s_waitcnt lgkmcnt(0)
    v_pk_min_u16 v56, v56, s51
    global_store_dword v19, v56, s[28:29] sc1
    s_endpgm
L_S7:
    v_lshrrev_b32 v5, 4, v0
    v_and_b32 v6, 15, v0
    s_lshl_b32 s61, s30, 2
    s_add_u32 s61, s61, s48
    v_lshrrev_b32 v16, 1, v0
    v_bfe_u32 v17, v0, 4, 1
    v_lshlrev_b32 v17, 2, v17
    v_xor_b32 v16, v16, v17
    v_and_b32 v17, 1, v0
    v_lshlrev_b32 v17, 4, v17
    v_lshl_add_u32 v8, v16, 10, v17
    s_lshl_b32 s51, s61, 5
    s_sub_u32 s52, 1409024, s51
    s_mov_b32 s36, s22
    s_mov_b32 s37, s23
    s_add_u32 s36, s36, s51
    s_addc_u32 s37, s37, 0
    s_mov_b32 s38, 0x0
    s_mov_b32 s39, 0x20000
    s_mov_b32 s38, s52
    s_mul_i32 m0, s33, 11264
    s_mul_i32 s50, s33, 360448
    buffer_load_dwordx4 v8, s[36:39], s50 offen lds
    s_add_u32 m0, m0, 0x400
    s_add_u32 s50, s50, 0x8000
    buffer_load_dwordx4 v8, s[36:39], s50 offen lds
    s_add_u32 m0, m0, 0x400
    s_add_u32 s50, s50, 0x8000
    buffer_load_dwordx4 v8, s[36:39], s50 offen lds
    s_add_u32 m0, m0, 0x400
    s_add_u32 s50, s50, 0x8000
    buffer_load_dwordx4 v8, s[36:39], s50 offen lds
    s_add_u32 m0, m0, 0x400
    s_add_u32 s50, s50, 0x8000
    buffer_load_dwordx4 v8, s[36:39], s50 offen lds
    s_add_u32 m0, m0, 0x400
    s_add_u32 s50, s50, 0x8000
    buffer_load_dwordx4 v8, s[36:39], s50 offen lds
    s_add_u32 m0, m0, 0x400
    s_add_u32 s50, s50, 0x8000
    buffer_load_dwordx4 v8, s[36:39], s50 offen lds
    s_add_u32 m0, m0, 0x400
    s_add_u32 s50, s50, 0x8000
    buffer_load_dwordx4 v8, s[36:39], s50 offen lds
    s_add_u32 m0, m0, 0x400
    s_add_u32 s50, s50, 0x8000
    buffer_load_dwordx4 v8, s[36:39], s50 offen lds
    s_add_u32 m0, m0, 0x400
    s_add_u32 s50, s50, 0x8000
    buffer_load_dwordx4 v8, s[36:39], s50 offen lds
    s_add_u32 m0, m0, 0x400
    s_add_u32 s50, s50, 0x8000
    buffer_load_dwordx4 v8, s[36:39], s50 offen lds
    s_lshl_b32 s51, s33, 10
    s_lshl_b32 s52, s61, 5
    s_add_u32 s51, s51, s52
    v_and_b32 v16, 7, v0
    v_lshlrev_b32 v16, 2, v16
    v_add_u32 v10, s51, v16
    global_load_dword v12, v10, s[4:5]
    s_lshl_b32 s51, s33, 15
    s_add_u32 s51, s51, s52
    s_add_u32 s51, s51, 0x30000
    v_lshrrev_b32 v17, 3, v0
    v_lshl_add_u32 v17, v17, 12, v16
    v_add_u32 v11, s51, v17
    v_lshrrev_b32 v16, 2, v6
    v_lshl_add_u32 v16, v5, 3, v16
    v_and_b32 v17, 1, v5
    v_lshlrev_b32 v17, 2, v17
    v_xor_b32 v16, v16, v17
    v_lshlrev_b32 v16, 5, v16
    v_and_b32 v17, 3, v6
    v_lshl_add_u32 v16, v17, 3, v16
    s_mul_i32 s51, s33, 11264
    v_add_u32 v14, s51, v16
    v_xor_b32 v16, 128, v16
    v_add_u32 v15, s51, v16
    v_lshrrev_b32 v16, 2, v6
    v_mul_u32_u24 v16, 2816, v16
    v_lshl_add_u32 v16, v5, 4, v16
    s_mul_i32 s51, s33, 704
    s_add_u32 s51, s51, 0x50000
    v_add_u32 v18, s51, v16
    s_movk_i32 s52, 640
    s_cmp_eq_u32 s33, 3
    s_cselect_b32 s51, 576, s52
    v_add_u32 v19, s51, v18
    s_lshl_b32 s51, s33, 6
    s_add_u32 s51, s51, 49152
    v_and_b32 v16, 7, v0
    v_lshlrev_b32 v16, 3, v16
    v_add_u32 v20, s51, v16
    s_lshl_b32 s51, s33, 8
    s_add_u32 s51, s51, 49408
    v_lshlrev_b32 v16, 2, v0
    v_add_u32 v21, s51, v16
    v_add_u32 v22, 49408, v16
    v_add_u32 v23, 49152, v16
    s_lshl_b32 s51, s61, 5
    v_lshlrev_b32 v16, 10, v5
    v_lshl_add_u32 v16, v6, 1, v16
    v_add_u32 v24, s51, v16
    s_waitcnt vmcnt(0)
    ds_read_b64_tr_b16 a[0:1], v14 offset:0
    ds_read_b64_tr_b16 a[2:3], v15 offset:0
    ds_read_b64_tr_b16 a[4:5], v14 offset:1024
    ds_read_b64_tr_b16 a[6:7], v15 offset:1024
    ds_read_b64_tr_b16 a[8:9], v14 offset:2048
    ds_read_b64_tr_b16 a[10:11], v15 offset:2048
    ds_read_b64_tr_b16 a[12:13], v14 offset:3072
    ds_read_b64_tr_b16 a[14:15], v15 offset:3072
    ds_read_b64_tr_b16 a[16:17], v14 offset:4096
    ds_read_b64_tr_b16 a[18:19], v15 offset:4096
    ds_read_b64_tr_b16 a[20:21], v14 offset:5120
    ds_read_b64_tr_b16 a[22:23], v15 offset:5120
    ds_read_b64_tr_b16 a[24:25], v14 offset:6144
    ds_read_b64_tr_b16 a[26:27], v15 offset:6144
    ds_read_b64_tr_b16 a[28:29], v14 offset:7168
    ds_read_b64_tr_b16 a[30:31], v15 offset:7168
    ds_read_b64_tr_b16 a[32:33], v14 offset:8192
    ds_read_b64_tr_b16 a[34:35], v15 offset:8192
    ds_read_b64_tr_b16 a[36:37], v14 offset:9216
    ds_read_b64_tr_b16 a[38:39], v15 offset:9216
    ds_read_b64_tr_b16 a[40:41], v14 offset:10240
    ds_read_b64_tr_b16 a[42:43], v15 offset:10240
L_S7_r:
    global_load_dword v26, v11, s[28:29] offset:0 sc1
    global_load_dword v27, v11, s[28:29] offset:1024 sc1
    global_load_dword v28, v11, s[28:29] offset:2048 sc1
    global_load_dword v29, v11, s[28:29] offset:3072 sc1
    s_waitcnt vmcnt(0)
    v_max3_u32 v30, v26, v27, v28
    v_max_u32 v30, v30, v29
    v_cmp_eq_u32 vcc, -1, v30
    s_cbranch_vccz L_S7_rok
    s_sleep 8
    s_add_u32 s55, s55, 1
    s_cmp_gt_u32 s55, 0x40000
    s_cbranch_scc1 L_fail
    s_branch L_S7_r
L_S7_rok:
    v_lshlrev_b32 v32, 16, v26
    v_and_b32 v36, 0xffff0000, v26
    v_lshlrev_b32 v33, 16, v27
    v_and_b32 v37, 0xffff0000, v27
    v_lshlrev_b32 v34, 16, v28
    v_and_b32 v38, 0xffff0000, v28
    v_lshlrev_b32 v35, 16, v29
    v_and_b32 v39, 0xffff0000, v29
    v_add_f32 v32, v32, v33
    v_add_f32 v34, v34, v35
    v_add_f32 v32, v32, v34
    v_add_f32 v36, v36, v37
    v_add_f32 v38, v38, v39
    v_add_f32 v36, v36, v38
    s_nop 1
    v_add_f32_dpp v32, v32, v32 row_ror:8 row_mask:0xf bank_mask:0xf
    v_add_f32_dpp v36, v36, v36 row_ror:8 row_mask:0xf bank_mask:0xf
    v_mov_b32 v33, v32
    v_mov_b32 v37, v36
    s_nop 1
    v_permlane16_swap_b32 v32, v33
    v_permlane16_swap_b32 v36, v37
    v_add_f32 v32, v32, v33
    v_add_f32 v36, v36, v37
    v_mov_b32 v33, v32
    v_mov_b32 v37, v36
    s_nop 1
    v_permlane32_swap_b32 v32, v33
    v_permlane32_swap_b32 v36, v37
    v_add_f32 v32, v32, v33
    v_add_f32 v36, v36, v37
    v_lshlrev_b32 v33, 16, v12
    v_and_b32 v37, 0xffff0000, v12
    v_add_f32 v32, v32, v33
    v_add_f32 v33, v36, v37
    ds_write_b64 v20, v[32:33]
L_S7_g:
    global_load_dwordx4 v[64:67], v18, s[28:29] offset:0 sc1
    global_load_dwordx4 v[68:71], v18, s[28:29] offset:64 sc1
    global_load_dwordx4 v[72:75], v18, s[28:29] offset:128 sc1
    global_load_dwordx4 v[76:79], v18, s[28:29] offset:192 sc1
    global_load_dwordx4 v[80:83], v18, s[28:29] offset:256 sc1
    global_load_dwordx4 v[84:87], v18, s[28:29] offset:320 sc1
    global_load_dwordx4 v[88:91], v18, s[28:29] offset:384 sc1
    global_load_dwordx4 v[92:95], v18, s[28:29] offset:448 sc1
    global_load_dwordx4 v[96:99], v18, s[28:29] offset:512 sc1
    global_load_dwordx4 v[100:103], v18, s[28:29] offset:576 sc1
    global_load_dwordx4 v[104:107], v19, s[28:29] sc1
    s_waitcnt vmcnt(0)
    v_max3_u32 v30, v64, v65, v66
    v_max3_u32 v30, v30, v67, v68
    v_max3_u32 v30, v30, v69, v70
    v_max3_u32 v30, v30, v71, v72
    v_max3_u32 v30, v30, v73, v74
    v_max3_u32 v30, v30, v75, v76
    v_max3_u32 v30, v30, v77, v78
    v_max3_u32 v30, v30, v79, v80
    v_max3_u32 v30, v30, v81, v82
    v_max3_u32 v30, v30, v83, v84
    v_max3_u32 v30, v30, v85, v86
    v_max3_u32 v30, v30, v87, v88
    v_max3_u32 v30, v30, v89, v90
    v_max3_u32 v30, v30, v91, v92
    v_max3_u32 v30, v30, v93, v94
    v_max3_u32 v30, v30, v95, v96
    v_max3_u32 v30, v30, v97, v98
    v_max3_u32 v30, v30, v99, v100
    v_max3_u32 v30, v30, v101, v102
    v_max3_u32 v30, v30, v103, v104
    v_max3_u32 v30, v30, v105, v106
    v_max_u32 v30, v30, v107
    v_cmp_eq_u32 vcc, -1, v30
    s_cbranch_vccz L_S7_gok
    s_sleep 2
    s_add_u32 s55, s55, 1
    s_cmp_gt_u32 s55, 0x40000
    s_cbranch_scc1 L_fail
    s_branch L_S7_g
L_S7_gok:
    s_waitcnt lgkmcnt(0)
    v_mfma_f32_16x16x32_bf16 v[40:43], v[64:67], a[0:3], 0
    v_mfma_f32_16x16x32_bf16 v[40:43], v[68:71], a[4:7], v[40:43]
    v_mfma_f32_16x16x32_bf16 v[40:43], v[72:75], a[8:11], v[40:43]
    v_mfma_f32_16x16x32_bf16 v[40:43], v[76:79], a[12:15], v[40:43]
    v_mfma_f32_16x16x32_bf16 v[40:43], v[80:83], a[16:19], v[40:43]
    v_mfma_f32_16x16x32_bf16 v[40:43], v[84:87], a[20:23], v[40:43]
    v_mfma_f32_16x16x32_bf16 v[40:43], v[88:91], a[24:27], v[40:43]
    v_mfma_f32_16x16x32_bf16 v[40:43], v[92:95], a[28:31], v[40:43]
    v_mfma_f32_16x16x32_bf16 v[40:43], v[96:99], a[32:35], v[40:43]
    v_mfma_f32_16x16x32_bf16 v[40:43], v[100:103], a[36:39], v[40:43]
    v_mfma_f32_16x16x32_bf16 v[40:43], v[104:107], a[40:43], v[40:43]
    s_nop 7
    ds_write_b32 v21, v40
    s_waitcnt lgkmcnt(0)
    s_barrier
    s_cmp_lg_u32 s33, 0
    s_cbranch_scc1 L_end
    ds_read_b32 v44, v22 offset:0
    ds_read_b32 v45, v22 offset:256
    ds_read_b32 v46, v22 offset:512
    ds_read_b32 v47, v22 offset:768
    ds_read_b32 v48, v23
    s_waitcnt lgkmcnt(0)
    v_add_f32 v44, v44, v45
    v_add_f32 v46, v46, v47
    v_add_f32 v44, v44, v48
    v_add_f32 v44, v44, v46
    s_nop 1
    v_mov_b32_dpp v45, v44 quad_perm:[1,0,3,2] row_mask:0xf bank_mask:0xf
    v_cvt_pk_bf16_f32 v44, v44, v45
    s_mov_b32 exec_lo, 0x55555555
    s_mov_b32 exec_hi, 0x55555555
    global_store_dword v24, v44, s[24:25]
    s_endpgm
L_fail:
    s_endpgm
L_end:
    s_endpgm
L_code_end:
.section .rodata,"a"
.p2align 6
.amdhsa_kernel sequential_preLN__compressed_kv_cla__glu_gated_reglu__decode_kernel
  .amdhsa_next_free_vgpr 512
  .amdhsa_next_free_sgpr 102
  .amdhsa_accum_offset 256
  .amdhsa_group_segment_fixed_size 0
  .amdhsa_kernarg_size 104
  .amdhsa_user_sgpr_count 2
  .amdhsa_user_sgpr_kernarg_segment_ptr 1
  .amdhsa_system_sgpr_workgroup_id_x 1
  .amdhsa_float_denorm_mode_32 3
.end_amdhsa_kernel
```
